```python
import torch

def _softmax(x, axis=-1):
    return torch.softmax(x, dim=axis)
def _gelu(x):
    return torch.nn.functional.gelu(x, approximate="tanh")
def _silu(x):
    return torch.nn.functional.silu(x)
def _sigmoid(x):
    return torch.sigmoid(x)
def _layernorm(x, axis=-1, eps=1e-5):
    m = x.mean(dim=axis, keepdim=True)
    v = x.var(dim=axis, keepdim=True, unbiased=False)
    return (x - m) / torch.sqrt(v + eps)
def _scatter_add(tgt, idx, src, axis=0):
    return tgt.clone().index_add_(axis, idx, src)
def _segment_sum(src, seg, n):
    out = torch.zeros((n,) + src.shape[1:], dtype=src.dtype)
    return out.index_add_(0, seg, src)
def _pad(x, pw):
    flat = tuple(v for pair in reversed(pw) for v in pair)
    return torch.nn.functional.pad(x, flat)

kernel_name = 'standalone__gqa_softmax__near_ridge'

def setup_inputs():

    _w = (lambda a: (lambda t: t.to(torch.bfloat16) if t.is_floating_point() else t)(torch.as_tensor(a)))
    B, Hq, Hkv, Sq, Sk, D = 16, 32, 8, 256, 256, 128
    return {
        "q": _w((lambda *s: torch.randn(*s, dtype=torch.bfloat16) * 0.8)(B, Hq, Sq, D)),
        "k": _w((lambda *s: torch.randn(*s, dtype=torch.bfloat16) * 0.8)(B, Hkv, Sk, D)),
        "v": _w((lambda *s: torch.randn(*s, dtype=torch.bfloat16) * 0.05)(B, Hkv, Sk, D)),
    }

def reference(q, k, v):
    B, Hq, Sq, D = q.shape
    Hkv = k.shape[1]
    rep = Hq // Hkv
    k = (lambda x, n, axis: torch.repeat_interleave(x, n, dim=axis))(k, rep, axis=1)
    v = (lambda x, n, axis: torch.repeat_interleave(x, n, dim=axis))(v, rep, axis=1)
    scale = D ** -0.5
    scores = torch.einsum("bhqd,bhkd->bhqk", q, k) * scale
    p = _softmax(scores, axis=-1)
    return torch.einsum("bhqk,bhkd->bhqd", p, v)
```

```asm
; @launch grid=(256,1,1) block=(512,1,1) lds=163840
.amdgcn_target "amdgcn-amd-amdhsa--gfx950"
.text
.globl standalone__gqa_softmax__near_ridge_kernel
.p2align 8
.type standalone__gqa_softmax__near_ridge_kernel,@function
standalone__gqa_softmax__near_ridge_kernel:
    s_cmp_ge_u32 s2, 256
    s_cbranch_scc1 L_end
    s_load_dwordx8 s[4:11], s[0:1], 0
    v_lshrrev_b32 v209, 6, v0
    v_and_b32 v208, 63, v0
    v_readfirstlane_b32 s28, v209
    s_getpc_b64 s[52:53]
L_pc:
    s_cmp_lt_u32 s28, 4
    s_cbranch_scc1 L_nopf
    v_and_b32 v1, 0xff, v0
    v_lshlrev_b32 v1, 7, v1
    v_min_u32 v2, L_exact-L_pc, v1
    global_load_dword v8, v2, s[52:53]
    v_add_u32 v1, 0x8000, v1
    v_min_u32 v3, L_exact-L_pc, v1
    global_load_dword v9, v3, s[52:53]
L_nopf:
    v_and_b32 v210, 15, v208
    v_lshrrev_b32 v211, 4, v208
    v_and_b32 v213, 3, v209
    s_and_b32 s3, s2, 7
    s_lshr_b32 s47, s2, 4
    s_lshl_b32 s47, s47, 3
    s_or_b32 s3, s3, s47
    s_bfe_u32 s48, s2, 0x10003
    s_lshl_b32 s47, s3, 16
    s_lshl_b32 s49, s3, 18
    s_lshl_b32 s48, s48, 17
    s_add_u32 s49, s49, s48
    s_mov_b32 s14, 0x20000
    s_mov_b32 s15, 0x20000
    s_mov_b32 s18, 0x10000
    s_mov_b32 s19, 0x20000
    s_mov_b32 s22, 0x10000
    s_mov_b32 s23, 0x20000
    s_mov_b32 s26, 0x20000
    s_mov_b32 s27, 0x20000
    v_lshlrev_b32 v214, 4, v210
    v_lshl_add_u32 v214, v211, 8, v214
    v_lshl_add_u32 v244, v213, 10, v214
    v_lshl_add_u32 v245, v213, 13, v214
    v_xor_b32 v219, v210, v211
    v_lshlrev_b32 v219, 4, v219
    v_lshl_add_u32 v248, v211, 8, v219
    v_xor_b32 v249, 64, v248
    v_xor_b32 v253, 0x80, v248
    v_xor_b32 v254, 0xc0, v248
    s_lshl_b32 s29, s28, 13
    s_lshl_b32 s30, s28, 14
    s_mov_b32 s46, 0x8000
    s_cmp_ge_u32 s28, 4
    s_cselect_b64 vcc, -1, 0
    s_waitcnt lgkmcnt(0)
    s_add_u32 s16, s6, s47
    s_addc_u32 s17, s7, 0
    s_add_u32 s12, s4, s49
    s_addc_u32 s13, s5, 0
    s_add_u32 s20, s8, s47
    s_addc_u32 s21, s9, 0
    s_cbranch_vccnz L_Aq
    buffer_load_dwordx4 v[64:67], v244, s[16:19], 0 offen offset:0
    s_mov_b32 s47, 0x1000
    buffer_load_dwordx4 v[68:71], v244, s[16:19], s47 offen offset:0
    s_mov_b32 s47, 0x2000
    buffer_load_dwordx4 v[72:75], v244, s[16:19], s47 offen offset:0
    s_mov_b32 s47, 0x3000
    buffer_load_dwordx4 v[76:79], v244, s[16:19], s47 offen offset:0
    s_mov_b32 s47, 0x4000
    buffer_load_dwordx4 v[80:83], v244, s[16:19], s47 offen offset:0
    s_mov_b32 s47, 0x5000
    buffer_load_dwordx4 v[84:87], v244, s[16:19], s47 offen offset:0
    s_mov_b32 s47, 0x6000
    buffer_load_dwordx4 v[88:91], v244, s[16:19], s47 offen offset:0
    s_mov_b32 s47, 0x7000
    buffer_load_dwordx4 v[92:95], v244, s[16:19], s47 offen offset:0
    s_add_u32 m0, s29, 0x20000
    s_xor_b32 s31, s30, 0x10000
    buffer_load_dwordx4 v248, s[12:15], s31 offen offset:0  lds
    buffer_load_dwordx4 v249, s[12:15], s31 offen offset:1024  lds
    buffer_load_dwordx4 v253, s[12:15], s31 offen offset:2048  lds
    buffer_load_dwordx4 v254, s[12:15], s31 offen offset:3072  lds
L_Aq:
    s_add_u32 s24, s10, s49
    s_addc_u32 s25, s11, 0
    s_mov_b32 s32, 0
    s_movk_i32 s33, 0x1000
    s_movk_i32 s34, 0x2000
    s_movk_i32 s35, 0x3000
    v_and_b32 v221, 3, v210
    v_lshrrev_b32 v222, 2, v210
    v_lshl_or_b32 v221, v221, 2, v222
    v_xor_b32 v219, v221, v211
    v_lshlrev_b32 v219, 4, v219
    v_lshl_add_u32 v219, v221, 8, v219
    v_lshl_add_u32 v219, v213, 13, v219
    v_add_u32 v251, 0x20000, v219
    v_and_b32 v220, 1, v210
    v_add_u32 v250, 0x10000, v214
    v_mul_u32_u24 v220, 0x3f80, v220
    v_lshl_or_b32 v220, v220, 16, v220
    v_xor_b32 v236, 0x3f803f80, v220
    v_mov_b32 v240, v220
    v_xor_b32 v237, 0x3f803f80, v220
    v_mov_b32 v241, v220
    v_xor_b32 v238, 0x3f803f80, v220
    v_mov_b32 v242, v220
    v_xor_b32 v239, 0x3f803f80, v220
    v_mov_b32 v243, v220
    v_lshlrev_b32 v219, 4, v210
    v_lshl_add_u32 v219, v211, 8, v219
    v_lshl_add_u32 v252, v209, 14, v219
    s_mov_b32 s36, 0x47800000
    s_mov_b32 s37, 0x37800000
    s_cbranch_vccz L_B
    s_mov_b64 vcc, 0
    v_xor_b32 v244, 0x40, v251
    v_xor_b32 v245, 0x80, v251
    v_xor_b32 v246, 0xc0, v251
    v_bfe_u32 v253, v252, 6, 4
    v_and_b32 v254, 0x1c030, v252
    v_lshl_add_u32 v254, v253, 8, v254
    v_bfe_u32 v255, v252, 8, 2
    v_bfe_u32 v253, v252, 6, 2
    v_lshl_add_u32 v255, v253, 2, v255
    v_and_b32 v253, 0x30, v252
    v_add_lshl_u32 v255, v253, v255, 2
    s_waitcnt vmcnt(0)
    s_barrier
    ds_read_b128 v[152:155], v251 offset:0
    ds_read_b128 v[148:151], v251 offset:4096
    ds_read_b128 v[196:199], v248 offset:0
    ds_read_b128 v[144:147], v244 offset:0
    ds_read_b128 v[140:143], v244 offset:4096
    ds_read_b128 v[200:203], v249 offset:1024
    ds_read_b128 v[136:139], v245 offset:0
    ds_read_b128 v[132:135], v245 offset:4096
    ds_read_b128 v[204:207], v248 offset:2048
    ds_read_b128 v[128:131], v246 offset:0
    ds_read_b128 v[124:127], v246 offset:4096
    ds_read_b128 v[208:211], v249 offset:3072
    ds_read_b128 v[212:215], v248 offset:4096
    ds_read_b128 v[216:219], v249 offset:5120
    ds_read_b128 v[220:223], v248 offset:6144
    s_setprio 3
    s_waitcnt lgkmcnt(11)
    v_mfma_f32_16x16x32_bf16 v[116:119], v[196:199], v[152:155], 0
    ds_read_b128 v[224:227], v249 offset:7168
    ds_read_b128 v[228:231], v248 offset:8192
    v_mfma_f32_16x16x32_bf16 v[112:115], v[196:199], v[148:151], 0
    ds_read_b128 v[232:235], v249 offset:9216
    s_waitcnt lgkmcnt(12)
    v_mfma_f32_16x16x32_bf16 v[116:119], v[200:203], v[144:147], v[116:119]
    v_mfma_f32_16x16x32_bf16 v[112:115], v[200:203], v[140:143], v[112:115]
    ds_read_b128 v[196:199], v248 offset:10240
    s_waitcnt lgkmcnt(9)
    v_mfma_f32_16x16x32_bf16 v[116:119], v[204:207], v[136:139], v[116:119]
    v_mfma_f32_16x16x32_bf16 v[112:115], v[204:207], v[132:135], v[112:115]
    ds_read_b128 v[200:203], v249 offset:11264
    s_waitcnt lgkmcnt(8)
    v_mfma_f32_16x16x32_bf16 v[116:119], v[208:211], v[128:131], v[116:119]
    v_mfma_f32_16x16x32_bf16 v[112:115], v[208:211], v[124:127], v[112:115]
    ds_read_b128 v[204:207], v248 offset:12288
    s_waitcnt lgkmcnt(7)
    v_mfma_f32_16x16x32_bf16 v[4:7], v[212:215], v[152:155], 0
    v_mfma_f32_16x16x32_bf16 v[0:3], v[212:215], v[148:151], 0
    ds_read_b128 v[208:211], v249 offset:13312
    v_mfma_f32_16x16x32_bf16 v[4:7], v[216:219], v[144:147], v[4:7]
    v_mfma_f32_16x16x32_bf16 v[0:3], v[216:219], v[140:143], v[0:3]
    ds_read_b128 v[212:215], v248 offset:14336
    v_max3_f32 v8, v116, v117, v118
    v_max3_f32 v8, v8, v119, v112
    s_waitcnt lgkmcnt(7)
    v_mfma_f32_16x16x32_bf16 v[4:7], v[220:223], v[136:139], v[4:7]
    v_max3_f32 v8, v8, v113, v114
    v_max_f32 v8, v8, v115
    v_mfma_f32_16x16x32_bf16 v[0:3], v[220:223], v[132:135], v[0:3]
    ds_read_b128 v[216:219], v249 offset:15360
    v_mov_b32 v9, v8
    v_mfma_f32_16x16x32_bf16 v[4:7], v[224:227], v[128:131], v[4:7]
    v_mfma_f32_16x16x32_bf16 v[0:3], v[224:227], v[124:127], v[0:3]
    ds_read_b128 v[220:223], v248 offset:16384
    v_permlane32_swap_b32 v8, v9
    s_waitcnt lgkmcnt(7)
    v_mfma_f32_16x16x32_bf16 v[100:103], v[228:231], v[152:155], 0
    v_max_f32 v8, v8, v9
    v_mov_b32 v9, v8
    v_mfma_f32_16x16x32_bf16 v[96:99], v[228:231], v[148:151], 0
    ds_read_b128 v[224:227], v249 offset:17408
    v_mfma_f32_16x16x32_bf16 v[100:103], v[232:235], v[144:147], v[100:103]
    v_permlane16_swap_b32 v8, v9
    v_mfma_f32_16x16x32_bf16 v[96:99], v[232:235], v[140:143], v[96:99]
    ds_read_b128 v[228:231], v248 offset:18432
    v_min_f32_e64 v244, -v8, -v9
    v_min_f32_e64 v245, -v8, -v9
    v_min_f32_e64 v246, -v8, -v9
    v_min_f32_e64 v247, -v8, -v9
    s_waitcnt lgkmcnt(7)
    v_mfma_f32_16x16x32_bf16 v[100:103], v[196:199], v[136:139], v[100:103]
    v_add_f32 v116, v116, v244
    v_add_f32 v117, v117, v244
    v_mfma_f32_16x16x32_bf16 v[96:99], v[196:199], v[132:135], v[96:99]
    ds_read_b128 v[232:235], v249 offset:19456
    v_add_f32 v118, v118, v244
    v_mfma_f32_16x16x32_bf16 v[100:103], v[200:203], v[128:131], v[100:103]
    v_add_f32 v119, v119, v244
    v_mfma_f32_16x16x32_bf16 v[96:99], v[200:203], v[124:127], v[96:99]
    ds_read_b128 v[196:199], v248 offset:20480
    s_waitcnt lgkmcnt(7)
    v_mfma_f32_16x16x32_bf16 v[120:123], v[204:207], v[152:155], v[244:247]
    v_exp_f32 v116, v116
    v_mfma_f32_16x16x32_bf16 v[108:111], v[204:207], v[148:151], v[244:247]
    ds_read_b128 v[200:203], v249 offset:21504
    v_mfma_f32_16x16x32_bf16 v[120:123], v[208:211], v[144:147], v[120:123]
    v_exp_f32 v117, v117
    v_mfma_f32_16x16x32_bf16 v[108:111], v[208:211], v[140:143], v[108:111]
    ds_read_b128 v[204:207], v248 offset:22528
    s_waitcnt lgkmcnt(7)
    v_mfma_f32_16x16x32_bf16 v[120:123], v[212:215], v[136:139], v[120:123]
    v_exp_f32 v118, v118
    v_mfma_f32_16x16x32_bf16 v[108:111], v[212:215], v[132:135], v[108:111]
    ds_read_b128 v[208:211], v249 offset:23552
    v_cvt_pk_bf16_f32 v116, v116, v117
    v_mfma_f32_16x16x32_bf16 v[120:123], v[216:219], v[128:131], v[120:123]
    v_exp_f32 v119, v119
    v_mfma_f32_16x16x32_bf16 v[108:111], v[216:219], v[124:127], v[108:111]
    ds_read_b128 v[212:215], v248 offset:24576
    s_waitcnt lgkmcnt(7)
    v_mfma_f32_16x16x32_bf16 v[84:87], v[220:223], v[152:155], v[244:247]
    v_add_f32 v112, v112, v244
    v_add_f32 v113, v113, v244
    v_mfma_f32_16x16x32_bf16 v[80:83], v[220:223], v[148:151], v[244:247]
    ds_read_b128 v[216:219], v249 offset:25600
    v_add_f32 v114, v114, v244
    v_mfma_f32_16x16x32_bf16 v[84:87], v[224:227], v[144:147], v[84:87]
    v_add_f32 v115, v115, v244
    v_cvt_pk_bf16_f32 v117, v118, v119
    v_mfma_f32_16x16x32_bf16 v[80:83], v[224:227], v[140:143], v[80:83]
    ds_read_b128 v[220:223], v248 offset:26624
    s_waitcnt lgkmcnt(7)
    v_mfma_f32_16x16x32_bf16 v[84:87], v[228:231], v[136:139], v[84:87]
    v_exp_f32 v112, v112
    v_mfma_f32_16x16x32_bf16 v[80:83], v[228:231], v[132:135], v[80:83]
    ds_read_b128 v[224:227], v249 offset:27648
    v_mfma_f32_16x16x32_bf16 v[84:87], v[232:235], v[128:131], v[84:87]
    v_exp_f32 v113, v113
    v_mfma_f32_16x16x32_bf16 v[80:83], v[232:235], v[124:127], v[80:83]
    ds_read_b128 v[228:231], v248 offset:28672
    s_waitcnt lgkmcnt(7)
    v_mfma_f32_16x16x32_bf16 v[104:107], v[196:199], v[152:155], v[244:247]
    v_exp_f32 v114, v114
    v_mfma_f32_16x16x32_bf16 v[92:95], v[196:199], v[148:151], v[244:247]
    ds_read_b128 v[232:235], v249 offset:29696
    v_cvt_pk_bf16_f32 v112, v112, v113
    v_mfma_f32_16x16x32_bf16 v[104:107], v[200:203], v[144:147], v[104:107]
    v_exp_f32 v115, v115
    v_mfma_f32_16x16x32_bf16 v[92:95], v[200:203], v[140:143], v[92:95]
    ds_read_b128 v[196:199], v248 offset:30720
    s_waitcnt lgkmcnt(7)
    v_mfma_f32_16x16x32_bf16 v[104:107], v[204:207], v[136:139], v[104:107]
    v_add_f32 v4, v4, v244
    v_add_f32 v5, v5, v244
    v_mfma_f32_16x16x32_bf16 v[92:95], v[204:207], v[132:135], v[92:95]
    ds_read_b128 v[200:203], v249 offset:31744
    v_add_f32 v6, v6, v244
    v_mfma_f32_16x16x32_bf16 v[104:107], v[208:211], v[128:131], v[104:107]
    v_add_f32 v7, v7, v244
    v_cvt_pk_bf16_f32 v113, v114, v115
    v_mfma_f32_16x16x32_bf16 v[92:95], v[208:211], v[124:127], v[92:95]
    s_waitcnt lgkmcnt(6)
    v_mfma_f32_16x16x32_bf16 v[72:75], v[212:215], v[152:155], v[244:247]
    v_exp_f32 v4, v4
    v_mfma_f32_16x16x32_bf16 v[68:71], v[212:215], v[148:151], v[244:247]
    v_exp_f32 v5, v5
    v_mfma_f32_16x16x32_bf16 v[72:75], v[216:219], v[144:147], v[72:75]
    v_exp_f32 v6, v6
    v_mfma_f32_16x16x32_bf16 v[68:71], v[216:219], v[140:143], v[68:71]
    v_cvt_pk_bf16_f32 v118, v4, v5
    s_waitcnt lgkmcnt(4)
    v_mfma_f32_16x16x32_bf16 v[72:75], v[220:223], v[136:139], v[72:75]
    v_exp_f32 v7, v7
    v_mfma_f32_16x16x32_bf16 v[68:71], v[220:223], v[132:135], v[68:71]
    v_add_f32 v0, v0, v244
    v_add_f32 v1, v1, v244
    v_mfma_f32_16x16x32_bf16 v[72:75], v[224:227], v[128:131], v[72:75]
    v_add_f32 v2, v2, v244
    v_add_f32 v3, v3, v244
    v_mfma_f32_16x16x32_bf16 v[68:71], v[224:227], v[124:127], v[68:71]
    v_cvt_pk_bf16_f32 v119, v6, v7
    s_waitcnt lgkmcnt(2)
    v_mfma_f32_16x16x32_bf16 v[88:91], v[228:231], v[152:155], v[244:247]
    v_exp_f32 v0, v0
    v_mfma_f32_16x16x32_bf16 v[76:79], v[228:231], v[148:151], v[244:247]
    v_exp_f32 v1, v1
    v_mfma_f32_16x16x32_bf16 v[88:91], v[232:235], v[144:147], v[88:91]
    s_barrier
    ds_read_b128 v[204:207], v250 offset:0
    ds_read_b128 v[208:211], v250 offset:1024
    ds_read_b128 v[212:215], v250 offset:2048
    ds_read_b128 v[216:219], v250 offset:3072
    v_mfma_f32_16x16x32_bf16 v[76:79], v[232:235], v[140:143], v[76:79]
    ds_read_b128 v[220:223], v250 offset:32768
    ds_read_b128 v[224:227], v250 offset:33792
    s_waitcnt lgkmcnt(6)
    v_mfma_f32_16x16x32_bf16 v[88:91], v[196:199], v[136:139], v[88:91]
    ds_read_b128 v[228:231], v250 offset:34816
    v_cvt_pk_bf16_f32 v114, v0, v1
    v_mfma_f32_16x16x32_bf16 v[76:79], v[196:199], v[132:135], v[76:79]
    ds_read_b128 v[232:235], v250 offset:35840
    v_exp_f32 v2, v2
    v_mfma_f32_16x16x32_bf16 v[88:91], v[200:203], v[128:131], v[88:91]
    v_exp_f32 v3, v3
    v_mfma_f32_16x16x32_bf16 v[76:79], v[200:203], v[124:127], v[76:79]
    ds_read_b128 v[196:199], v250 offset:4096
    v_cvt_pk_bf16_f32 v115, v2, v3
    s_waitcnt lgkmcnt(7)
    v_mfma_f32_16x16x32_bf16 v[28:31], v[116:119], v[204:207], 0
    v_add_f32 v100, v100, v244
    v_add_f32 v101, v101, v244
    v_mfma_f32_16x16x32_bf16 v[12:15], v[112:115], v[204:207], 0
    ds_read_b128 v[200:203], v250 offset:5120
    v_add_f32 v102, v102, v244
    v_mfma_f32_16x16x32_bf16 v[24:27], v[116:119], v[208:211], 0
    v_add_f32 v103, v103, v244
    v_exp_f32 v100, v100
    v_mfma_f32_16x16x32_bf16 v[8:11], v[112:115], v[208:211], 0
    ds_read_b128 v[204:207], v250 offset:6144
    v_exp_f32 v101, v101
    v_mfma_f32_16x16x32_bf16 v[36:39], v[116:119], v[236:239], 0
    v_exp_f32 v102, v102
    s_waitcnt lgkmcnt(7)
    v_mfma_f32_16x16x32_bf16 v[20:23], v[116:119], v[212:215], 0
    ds_read_b128 v[208:211], v250 offset:7168
    v_exp_f32 v103, v103
    v_add_f32 v96, v96, v244
    v_mfma_f32_16x16x32_bf16 v[4:7], v[112:115], v[212:215], 0
    v_add_f32 v97, v97, v244
    v_add_f32 v98, v98, v244
    v_add_f32 v99, v99, v244
    v_mfma_f32_16x16x32_bf16 v[16:19], v[116:119], v[216:219], 0
    v_exp_f32 v96, v96
    v_exp_f32 v97, v97
    v_mfma_f32_16x16x32_bf16 v[0:3], v[112:115], v[216:219], 0
    ds_read_b128 v[212:215], v250 offset:36864
    v_exp_f32 v98, v98
    s_waitcnt lgkmcnt(7)
    v_mfma_f32_16x16x32_bf16 v[64:67], v[116:119], v[220:223], 0
    v_exp_f32 v99, v99
    v_cvt_pk_bf16_f32 v100, v100, v101
    v_mfma_f32_16x16x32_bf16 v[48:51], v[112:115], v[220:223], 0
    ds_read_b128 v[216:219], v250 offset:37888
    v_exp_f32 v120, v120
    v_mfma_f32_16x16x32_bf16 v[36:39], v[112:115], v[240:243], v[36:39]
    v_exp_f32 v121, v121
    v_cvt_pk_bf16_f32 v101, v102, v103
    v_mfma_f32_16x16x32_bf16 v[60:63], v[116:119], v[224:227], 0
    ds_read_b128 v[220:223], v250 offset:38912
    v_exp_f32 v122, v122
    v_exp_f32 v123, v123
    v_cvt_pk_bf16_f32 v96, v96, v97
    v_mfma_f32_16x16x32_bf16 v[32:35], v[112:115], v[224:227], 0
    v_exp_f32 v108, v108
    s_waitcnt lgkmcnt(7)
    v_mfma_f32_16x16x32_bf16 v[56:59], v[116:119], v[228:231], 0
    v_exp_f32 v109, v109
    v_cvt_pk_bf16_f32 v97, v98, v99
    v_cvt_pk_bf16_f32 v102, v120, v121
    v_mfma_f32_16x16x32_bf16 v[44:47], v[112:115], v[228:231], 0
    ds_read_b128 v[224:227], v250 offset:39936
    v_exp_f32 v110, v110
    v_cvt_pk_bf16_f32 v103, v122, v123
    v_mfma_f32_16x16x32_bf16 v[52:55], v[116:119], v[232:235], 0
    v_exp_f32 v111, v111
    v_cvt_pk_bf16_f32 v98, v108, v109
    v_mfma_f32_16x16x32_bf16 v[40:43], v[112:115], v[232:235], 0
    ds_read_b128 v[228:231], v250 offset:8192
    v_cvt_pk_bf16_f32 v99, v110, v111
    s_waitcnt lgkmcnt(7)
    v_mfma_f32_16x16x32_bf16 v[28:31], v[100:103], v[196:199], v[28:31]
    v_exp_f32 v84, v84
    v_mfma_f32_16x16x32_bf16 v[12:15], v[96:99], v[196:199], v[12:15]
    ds_read_b128 v[232:235], v250 offset:9216
    v_mfma_f32_16x16x32_bf16 v[24:27], v[100:103], v[200:203], v[24:27]
    v_exp_f32 v85, v85
    v_mfma_f32_16x16x32_bf16 v[8:11], v[96:99], v[200:203], v[8:11]
    ds_read_b128 v[196:199], v250 offset:10240
    v_cvt_pk_bf16_f32 v84, v84, v85
    v_mfma_f32_16x16x32_bf16 v[36:39], v[100:103], v[236:239], v[36:39]
    s_waitcnt lgkmcnt(7)
    v_mfma_f32_16x16x32_bf16 v[20:23], v[100:103], v[204:207], v[20:23]
    ds_read_b128 v[200:203], v250 offset:11264
    v_exp_f32 v86, v86
    v_mfma_f32_16x16x32_bf16 v[4:7], v[96:99], v[204:207], v[4:7]
    v_exp_f32 v87, v87
    v_mfma_f32_16x16x32_bf16 v[16:19], v[100:103], v[208:211], v[16:19]
    v_exp_f32 v80, v80
    v_exp_f32 v81, v81
    v_mfma_f32_16x16x32_bf16 v[0:3], v[96:99], v[208:211], v[0:3]
    ds_read_b128 v[204:207], v250 offset:40960
    v_exp_f32 v82, v82
    s_waitcnt lgkmcnt(7)
    v_mfma_f32_16x16x32_bf16 v[64:67], v[100:103], v[212:215], v[64:67]
    v_exp_f32 v83, v83
    v_mfma_f32_16x16x32_bf16 v[48:51], v[96:99], v[212:215], v[48:51]
    ds_read_b128 v[208:211], v250 offset:41984
    v_exp_f32 v104, v104
    v_mfma_f32_16x16x32_bf16 v[36:39], v[96:99], v[240:243], v[36:39]
    v_exp_f32 v105, v105
    v_cvt_pk_bf16_f32 v85, v86, v87
    v_mfma_f32_16x16x32_bf16 v[60:63], v[100:103], v[216:219], v[60:63]
    ds_read_b128 v[212:215], v250 offset:43008
    v_exp_f32 v106, v106
    v_exp_f32 v107, v107
    v_cvt_pk_bf16_f32 v80, v80, v81
    v_mfma_f32_16x16x32_bf16 v[32:35], v[96:99], v[216:219], v[32:35]
    v_exp_f32 v92, v92
    s_waitcnt lgkmcnt(7)
    v_mfma_f32_16x16x32_bf16 v[56:59], v[100:103], v[220:223], v[56:59]
    v_exp_f32 v93, v93
    v_cvt_pk_bf16_f32 v81, v82, v83
    v_cvt_pk_bf16_f32 v86, v104, v105
    v_mfma_f32_16x16x32_bf16 v[44:47], v[96:99], v[220:223], v[44:47]
    ds_read_b128 v[216:219], v250 offset:44032
    v_exp_f32 v94, v94
    v_cvt_pk_bf16_f32 v87, v106, v107
    v_mfma_f32_16x16x32_bf16 v[52:55], v[100:103], v[224:227], v[52:55]
    v_exp_f32 v95, v95
    v_cvt_pk_bf16_f32 v82, v92, v93
    v_mfma_f32_16x16x32_bf16 v[40:43], v[96:99], v[224:227], v[40:43]
    ds_read_b128 v[220:223], v250 offset:12288
    v_cvt_pk_bf16_f32 v83, v94, v95
    s_waitcnt lgkmcnt(7)
    v_mfma_f32_16x16x32_bf16 v[28:31], v[84:87], v[228:231], v[28:31]
    v_exp_f32 v72, v72
    v_mfma_f32_16x16x32_bf16 v[12:15], v[80:83], v[228:231], v[12:15]
    ds_read_b128 v[224:227], v250 offset:13312
    v_mfma_f32_16x16x32_bf16 v[24:27], v[84:87], v[232:235], v[24:27]
    v_exp_f32 v73, v73
    v_mfma_f32_16x16x32_bf16 v[8:11], v[80:83], v[232:235], v[8:11]
    ds_read_b128 v[228:231], v250 offset:14336
    v_cvt_pk_bf16_f32 v72, v72, v73
    v_mfma_f32_16x16x32_bf16 v[36:39], v[84:87], v[236:239], v[36:39]
    s_waitcnt lgkmcnt(7)
    v_mfma_f32_16x16x32_bf16 v[20:23], v[84:87], v[196:199], v[20:23]
    ds_read_b128 v[232:235], v250 offset:15360
    v_exp_f32 v74, v74
    v_mfma_f32_16x16x32_bf16 v[4:7], v[80:83], v[196:199], v[4:7]
    v_exp_f32 v75, v75
    v_mfma_f32_16x16x32_bf16 v[16:19], v[84:87], v[200:203], v[16:19]
    v_exp_f32 v68, v68
    v_exp_f32 v69, v69
    v_mfma_f32_16x16x32_bf16 v[0:3], v[80:83], v[200:203], v[0:3]
    ds_read_b128 v[196:199], v250 offset:45056
    v_exp_f32 v70, v70
    s_waitcnt lgkmcnt(7)
    v_mfma_f32_16x16x32_bf16 v[64:67], v[84:87], v[204:207], v[64:67]
    v_exp_f32 v71, v71
    v_mfma_f32_16x16x32_bf16 v[48:51], v[80:83], v[204:207], v[48:51]
    ds_read_b128 v[200:203], v250 offset:46080
    v_exp_f32 v88, v88
    v_mfma_f32_16x16x32_bf16 v[36:39], v[80:83], v[240:243], v[36:39]
    v_exp_f32 v89, v89
    v_cvt_pk_bf16_f32 v73, v74, v75
    v_mfma_f32_16x16x32_bf16 v[60:63], v[84:87], v[208:211], v[60:63]
    ds_read_b128 v[204:207], v250 offset:47104
    v_exp_f32 v90, v90
    v_exp_f32 v91, v91
    v_cvt_pk_bf16_f32 v68, v68, v69
    v_mfma_f32_16x16x32_bf16 v[32:35], v[80:83], v[208:211], v[32:35]
    v_exp_f32 v76, v76
    s_waitcnt lgkmcnt(7)
    v_mfma_f32_16x16x32_bf16 v[56:59], v[84:87], v[212:215], v[56:59]
    v_exp_f32 v77, v77
    v_cvt_pk_bf16_f32 v69, v70, v71
    v_cvt_pk_bf16_f32 v74, v88, v89
    v_mfma_f32_16x16x32_bf16 v[44:47], v[80:83], v[212:215], v[44:47]
    ds_read_b128 v[208:211], v250 offset:48128
    v_exp_f32 v78, v78
    v_cvt_pk_bf16_f32 v75, v90, v91
    v_mfma_f32_16x16x32_bf16 v[52:55], v[84:87], v[216:219], v[52:55]
    v_exp_f32 v79, v79
    v_cvt_pk_bf16_f32 v70, v76, v77
    v_mfma_f32_16x16x32_bf16 v[40:43], v[80:83], v[216:219], v[40:43]
    v_cvt_pk_bf16_f32 v71, v78, v79
    s_waitcnt lgkmcnt(6)
    v_mfma_f32_16x16x32_bf16 v[28:31], v[72:75], v[220:223], v[28:31]
    v_mfma_f32_16x16x32_bf16 v[12:15], v[68:71], v[220:223], v[12:15]
    v_mfma_f32_16x16x32_bf16 v[24:27], v[72:75], v[224:227], v[24:27]
    v_mfma_f32_16x16x32_bf16 v[8:11], v[68:71], v[224:227], v[8:11]
    v_mfma_f32_16x16x32_bf16 v[36:39], v[72:75], v[236:239], v[36:39]
    s_waitcnt lgkmcnt(4)
    v_mfma_f32_16x16x32_bf16 v[20:23], v[72:75], v[228:231], v[20:23]
    v_mfma_f32_16x16x32_bf16 v[4:7], v[68:71], v[228:231], v[4:7]
    v_mfma_f32_16x16x32_bf16 v[16:19], v[72:75], v[232:235], v[16:19]
    v_mfma_f32_16x16x32_bf16 v[0:3], v[68:71], v[232:235], v[0:3]
    s_waitcnt lgkmcnt(2)
    v_mfma_f32_16x16x32_bf16 v[64:67], v[72:75], v[196:199], v[64:67]
    v_mfma_f32_16x16x32_bf16 v[48:51], v[68:71], v[196:199], v[48:51]
    v_mfma_f32_16x16x32_bf16 v[36:39], v[68:71], v[240:243], v[36:39]
    v_mfma_f32_16x16x32_bf16 v[60:63], v[72:75], v[200:203], v[60:63]
    s_barrier
    ds_read_b128 v[212:215], v248 offset:32768
    ds_read_b128 v[216:219], v249 offset:33792
    ds_read_b128 v[220:223], v248 offset:34816
    ds_read_b128 v[224:227], v249 offset:35840
    v_mfma_f32_16x16x32_bf16 v[32:35], v[68:71], v[200:203], v[32:35]
    ds_read_b128 v[228:231], v248 offset:36864
    ds_read_b128 v[232:235], v249 offset:37888
    s_waitcnt lgkmcnt(6)
    v_mfma_f32_16x16x32_bf16 v[56:59], v[72:75], v[204:207], v[56:59]
    ds_read_b128 v[196:199], v248 offset:38912
    v_mfma_f32_16x16x32_bf16 v[44:47], v[68:71], v[204:207], v[44:47]
    ds_read_b128 v[200:203], v249 offset:39936
    v_mfma_f32_16x16x32_bf16 v[52:55], v[72:75], v[208:211], v[52:55]
    v_mfma_f32_16x16x32_bf16 v[40:43], v[68:71], v[208:211], v[40:43]
    ds_read_b128 v[204:207], v248 offset:40960
    s_waitcnt lgkmcnt(7)
    v_mfma_f32_16x16x32_bf16 v[112:115], v[212:215], v[152:155], v[244:247]
    v_mfma_f32_16x16x32_bf16 v[108:111], v[212:215], v[148:151], v[244:247]
    ds_read_b128 v[208:211], v249 offset:41984
    v_mfma_f32_16x16x32_bf16 v[112:115], v[216:219], v[144:147], v[112:115]
    v_mfma_f32_16x16x32_bf16 v[108:111], v[216:219], v[140:143], v[108:111]
    ds_read_b128 v[212:215], v248 offset:43008
    s_waitcnt lgkmcnt(7)
    v_mfma_f32_16x16x32_bf16 v[112:115], v[220:223], v[136:139], v[112:115]
    v_mfma_f32_16x16x32_bf16 v[108:111], v[220:223], v[132:135], v[108:111]
    ds_read_b128 v[216:219], v249 offset:44032
    v_mfma_f32_16x16x32_bf16 v[112:115], v[224:227], v[128:131], v[112:115]
    v_mfma_f32_16x16x32_bf16 v[108:111], v[224:227], v[124:127], v[108:111]
    ds_read_b128 v[220:223], v248 offset:45056
    s_waitcnt lgkmcnt(7)
    v_mfma_f32_16x16x32_bf16 v[72:75], v[228:231], v[152:155], v[244:247]
    v_mfma_f32_16x16x32_bf16 v[68:71], v[228:231], v[148:151], v[244:247]
    ds_read_b128 v[224:227], v249 offset:46080
    v_mfma_f32_16x16x32_bf16 v[72:75], v[232:235], v[144:147], v[72:75]
    s_nop 0
    v_exp_f32 v112, v112
    v_mfma_f32_16x16x32_bf16 v[68:71], v[232:235], v[140:143], v[68:71]
    ds_read_b128 v[228:231], v248 offset:47104
    s_waitcnt lgkmcnt(7)
    v_mfma_f32_16x16x32_bf16 v[72:75], v[196:199], v[136:139], v[72:75]
    v_exp_f32 v113, v113
    v_mfma_f32_16x16x32_bf16 v[68:71], v[196:199], v[132:135], v[68:71]
    ds_read_b128 v[232:235], v249 offset:48128
    v_cvt_pk_bf16_f32 v112, v112, v113
    v_mfma_f32_16x16x32_bf16 v[72:75], v[200:203], v[128:131], v[72:75]
    v_exp_f32 v114, v114
    v_mfma_f32_16x16x32_bf16 v[68:71], v[200:203], v[124:127], v[68:71]
    ds_read_b128 v[196:199], v248 offset:49152
    s_waitcnt lgkmcnt(7)
    v_mfma_f32_16x16x32_bf16 v[100:103], v[204:207], v[152:155], v[244:247]
    v_exp_f32 v115, v115
    v_mfma_f32_16x16x32_bf16 v[96:99], v[204:207], v[148:151], v[244:247]
    ds_read_b128 v[200:203], v249 offset:50176
    v_cvt_pk_bf16_f32 v113, v114, v115
    v_mfma_f32_16x16x32_bf16 v[100:103], v[208:211], v[144:147], v[100:103]
    v_exp_f32 v108, v108
    v_mfma_f32_16x16x32_bf16 v[96:99], v[208:211], v[140:143], v[96:99]
    ds_read_b128 v[204:207], v248 offset:51200
    s_waitcnt lgkmcnt(7)
    v_mfma_f32_16x16x32_bf16 v[100:103], v[212:215], v[136:139], v[100:103]
    v_exp_f32 v109, v109
    v_mfma_f32_16x16x32_bf16 v[96:99], v[212:215], v[132:135], v[96:99]
    ds_read_b128 v[208:211], v249 offset:52224
    v_cvt_pk_bf16_f32 v108, v108, v109
    v_mfma_f32_16x16x32_bf16 v[100:103], v[216:219], v[128:131], v[100:103]
    v_exp_f32 v110, v110
    v_mfma_f32_16x16x32_bf16 v[96:99], v[216:219], v[124:127], v[96:99]
    ds_read_b128 v[212:215], v248 offset:53248
    s_waitcnt lgkmcnt(7)
    v_mfma_f32_16x16x32_bf16 v[120:123], v[220:223], v[152:155], v[244:247]
    v_exp_f32 v111, v111
    v_mfma_f32_16x16x32_bf16 v[116:119], v[220:223], v[148:151], v[244:247]
    ds_read_b128 v[216:219], v249 offset:54272
    v_cvt_pk_bf16_f32 v109, v110, v111
    v_mfma_f32_16x16x32_bf16 v[120:123], v[224:227], v[144:147], v[120:123]
    v_exp_f32 v72, v72
    v_mfma_f32_16x16x32_bf16 v[116:119], v[224:227], v[140:143], v[116:119]
    ds_read_b128 v[220:223], v248 offset:55296
    s_waitcnt lgkmcnt(7)
    v_mfma_f32_16x16x32_bf16 v[120:123], v[228:231], v[136:139], v[120:123]
    v_exp_f32 v73, v73
    v_mfma_f32_16x16x32_bf16 v[116:119], v[228:231], v[132:135], v[116:119]
    ds_read_b128 v[224:227], v249 offset:56320
    v_cvt_pk_bf16_f32 v114, v72, v73
    v_mfma_f32_16x16x32_bf16 v[120:123], v[232:235], v[128:131], v[120:123]
    v_exp_f32 v74, v74
    v_mfma_f32_16x16x32_bf16 v[116:119], v[232:235], v[124:127], v[116:119]
    ds_read_b128 v[228:231], v248 offset:57344
    s_waitcnt lgkmcnt(7)
    v_mfma_f32_16x16x32_bf16 v[84:87], v[196:199], v[152:155], v[244:247]
    v_exp_f32 v75, v75
    v_mfma_f32_16x16x32_bf16 v[80:83], v[196:199], v[148:151], v[244:247]
    ds_read_b128 v[232:235], v249 offset:58368
    v_cvt_pk_bf16_f32 v115, v74, v75
    v_mfma_f32_16x16x32_bf16 v[84:87], v[200:203], v[144:147], v[84:87]
    v_exp_f32 v68, v68
    v_mfma_f32_16x16x32_bf16 v[80:83], v[200:203], v[140:143], v[80:83]
    ds_read_b128 v[196:199], v248 offset:59392
    s_waitcnt lgkmcnt(7)
    v_mfma_f32_16x16x32_bf16 v[84:87], v[204:207], v[136:139], v[84:87]
    v_exp_f32 v69, v69
    v_mfma_f32_16x16x32_bf16 v[80:83], v[204:207], v[132:135], v[80:83]
    ds_read_b128 v[200:203], v249 offset:60416
    v_cvt_pk_bf16_f32 v110, v68, v69
    v_mfma_f32_16x16x32_bf16 v[84:87], v[208:211], v[128:131], v[84:87]
    v_exp_f32 v70, v70
    v_mfma_f32_16x16x32_bf16 v[80:83], v[208:211], v[124:127], v[80:83]
    ds_read_b128 v[204:207], v248 offset:61440
    s_waitcnt lgkmcnt(7)
    v_mfma_f32_16x16x32_bf16 v[104:107], v[212:215], v[152:155], v[244:247]
    v_exp_f32 v71, v71
    v_mfma_f32_16x16x32_bf16 v[92:95], v[212:215], v[148:151], v[244:247]
    ds_read_b128 v[208:211], v249 offset:62464
    v_cvt_pk_bf16_f32 v111, v70, v71
    v_mfma_f32_16x16x32_bf16 v[104:107], v[216:219], v[144:147], v[104:107]
    v_exp_f32 v100, v100
    v_mfma_f32_16x16x32_bf16 v[92:95], v[216:219], v[140:143], v[92:95]
    ds_read_b128 v[212:215], v248 offset:63488
    s_waitcnt lgkmcnt(7)
    v_mfma_f32_16x16x32_bf16 v[104:107], v[220:223], v[136:139], v[104:107]
    v_exp_f32 v101, v101
    v_mfma_f32_16x16x32_bf16 v[92:95], v[220:223], v[132:135], v[92:95]
    ds_read_b128 v[216:219], v249 offset:64512
    v_cvt_pk_bf16_f32 v100, v100, v101
    v_mfma_f32_16x16x32_bf16 v[104:107], v[224:227], v[128:131], v[104:107]
    v_exp_f32 v102, v102
    v_mfma_f32_16x16x32_bf16 v[92:95], v[224:227], v[124:127], v[92:95]
    s_waitcnt lgkmcnt(6)
    v_mfma_f32_16x16x32_bf16 v[72:75], v[228:231], v[152:155], v[244:247]
    v_exp_f32 v103, v103
    v_mfma_f32_16x16x32_bf16 v[68:71], v[228:231], v[148:151], v[244:247]
    v_exp_f32 v96, v96
    v_mfma_f32_16x16x32_bf16 v[72:75], v[232:235], v[144:147], v[72:75]
    v_exp_f32 v97, v97
    v_mfma_f32_16x16x32_bf16 v[68:71], v[232:235], v[140:143], v[68:71]
    v_cvt_pk_bf16_f32 v101, v102, v103
    s_waitcnt lgkmcnt(4)
    v_mfma_f32_16x16x32_bf16 v[72:75], v[196:199], v[136:139], v[72:75]
    v_exp_f32 v98, v98
    v_mfma_f32_16x16x32_bf16 v[68:71], v[196:199], v[132:135], v[68:71]
    v_exp_f32 v99, v99
    v_mfma_f32_16x16x32_bf16 v[72:75], v[200:203], v[128:131], v[72:75]
    v_exp_f32 v120, v120
    v_mfma_f32_16x16x32_bf16 v[68:71], v[200:203], v[124:127], v[68:71]
    v_cvt_pk_bf16_f32 v96, v96, v97
    s_waitcnt lgkmcnt(2)
    v_mfma_f32_16x16x32_bf16 v[88:91], v[204:207], v[152:155], v[244:247]
    v_exp_f32 v121, v121
    v_mfma_f32_16x16x32_bf16 v[76:79], v[204:207], v[148:151], v[244:247]
    v_exp_f32 v122, v122
    v_mfma_f32_16x16x32_bf16 v[88:91], v[208:211], v[144:147], v[88:91]
    s_barrier
    ds_read_b128 v[220:223], v250 offset:16384
    ds_read_b128 v[224:227], v250 offset:17408
    ds_read_b128 v[228:231], v250 offset:18432
    ds_read_b128 v[232:235], v250 offset:19456
    v_mfma_f32_16x16x32_bf16 v[76:79], v[208:211], v[140:143], v[76:79]
    ds_read_b128 v[196:199], v250 offset:49152
    ds_read_b128 v[200:203], v250 offset:50176
    s_waitcnt lgkmcnt(6)
    v_mfma_f32_16x16x32_bf16 v[88:91], v[212:215], v[136:139], v[88:91]
    ds_read_b128 v[204:207], v250 offset:51200
    v_cvt_pk_bf16_f32 v97, v98, v99
    v_mfma_f32_16x16x32_bf16 v[76:79], v[212:215], v[132:135], v[76:79]
    ds_read_b128 v[208:211], v250 offset:52224
    v_cvt_pk_bf16_f32 v102, v120, v121
    v_mfma_f32_16x16x32_bf16 v[88:91], v[216:219], v[128:131], v[88:91]
    v_exp_f32 v123, v123
    v_mfma_f32_16x16x32_bf16 v[76:79], v[216:219], v[124:127], v[76:79]
    ds_read_b128 v[212:215], v250 offset:20480
    s_waitcnt lgkmcnt(7)
    v_mfma_f32_16x16x32_bf16 v[28:31], v[112:115], v[220:223], v[28:31]
    v_exp_f32 v116, v116
    v_mfma_f32_16x16x32_bf16 v[12:15], v[108:111], v[220:223], v[12:15]
    ds_read_b128 v[216:219], v250 offset:21504
    v_cvt_pk_bf16_f32 v103, v122, v123
    v_mfma_f32_16x16x32_bf16 v[24:27], v[112:115], v[224:227], v[24:27]
    v_exp_f32 v117, v117
    v_mfma_f32_16x16x32_bf16 v[8:11], v[108:111], v[224:227], v[8:11]
    ds_read_b128 v[220:223], v250 offset:22528
    v_cvt_pk_bf16_f32 v98, v116, v117
    v_mfma_f32_16x16x32_bf16 v[36:39], v[112:115], v[236:239], v[36:39]
    s_waitcnt lgkmcnt(7)
    v_mfma_f32_16x16x32_bf16 v[20:23], v[112:115], v[228:231], v[20:23]
    ds_read_b128 v[224:227], v250 offset:23552
    v_mfma_f32_16x16x32_bf16 v[4:7], v[108:111], v[228:231], v[4:7]
    v_exp_f32 v118, v118
    v_mfma_f32_16x16x32_bf16 v[16:19], v[112:115], v[232:235], v[16:19]
    v_exp_f32 v119, v119
    v_mfma_f32_16x16x32_bf16 v[0:3], v[108:111], v[232:235], v[0:3]
    ds_read_b128 v[228:231], v250 offset:53248
    s_waitcnt lgkmcnt(7)
    v_mfma_f32_16x16x32_bf16 v[64:67], v[112:115], v[196:199], v[64:67]
    v_exp_f32 v84, v84
    v_mfma_f32_16x16x32_bf16 v[48:51], v[108:111], v[196:199], v[48:51]
    ds_read_b128 v[232:235], v250 offset:54272
    v_cvt_pk_bf16_f32 v99, v118, v119
    v_mfma_f32_16x16x32_bf16 v[36:39], v[108:111], v[240:243], v[36:39]
    v_exp_f32 v85, v85
    v_mfma_f32_16x16x32_bf16 v[60:63], v[112:115], v[200:203], v[60:63]
    ds_read_b128 v[196:199], v250 offset:55296
    v_cvt_pk_bf16_f32 v84, v84, v85
    v_mfma_f32_16x16x32_bf16 v[32:35], v[108:111], v[200:203], v[32:35]
    s_waitcnt lgkmcnt(7)
    v_mfma_f32_16x16x32_bf16 v[56:59], v[112:115], v[204:207], v[56:59]
    v_exp_f32 v86, v86
    v_mfma_f32_16x16x32_bf16 v[44:47], v[108:111], v[204:207], v[44:47]
    ds_read_b128 v[200:203], v250 offset:56320
    v_mfma_f32_16x16x32_bf16 v[52:55], v[112:115], v[208:211], v[52:55]
    v_exp_f32 v87, v87
    v_mfma_f32_16x16x32_bf16 v[40:43], v[108:111], v[208:211], v[40:43]
    ds_read_b128 v[204:207], v250 offset:24576
    s_waitcnt lgkmcnt(7)
    v_mfma_f32_16x16x32_bf16 v[28:31], v[100:103], v[212:215], v[28:31]
    v_exp_f32 v80, v80
    v_mfma_f32_16x16x32_bf16 v[12:15], v[96:99], v[212:215], v[12:15]
    ds_read_b128 v[208:211], v250 offset:25600
    v_cvt_pk_bf16_f32 v85, v86, v87
    v_mfma_f32_16x16x32_bf16 v[24:27], v[100:103], v[216:219], v[24:27]
    v_exp_f32 v81, v81
    v_mfma_f32_16x16x32_bf16 v[8:11], v[96:99], v[216:219], v[8:11]
    ds_read_b128 v[212:215], v250 offset:26624
    v_cvt_pk_bf16_f32 v80, v80, v81
    v_mfma_f32_16x16x32_bf16 v[36:39], v[100:103], v[236:239], v[36:39]
    s_waitcnt lgkmcnt(7)
    v_mfma_f32_16x16x32_bf16 v[20:23], v[100:103], v[220:223], v[20:23]
    ds_read_b128 v[216:219], v250 offset:27648
    v_mfma_f32_16x16x32_bf16 v[4:7], v[96:99], v[220:223], v[4:7]
    v_exp_f32 v82, v82
    v_mfma_f32_16x16x32_bf16 v[16:19], v[100:103], v[224:227], v[16:19]
    v_exp_f32 v83, v83
    v_mfma_f32_16x16x32_bf16 v[0:3], v[96:99], v[224:227], v[0:3]
    ds_read_b128 v[220:223], v250 offset:57344
    s_waitcnt lgkmcnt(7)
    v_mfma_f32_16x16x32_bf16 v[64:67], v[100:103], v[228:231], v[64:67]
    v_exp_f32 v104, v104
    v_mfma_f32_16x16x32_bf16 v[48:51], v[96:99], v[228:231], v[48:51]
    ds_read_b128 v[224:227], v250 offset:58368
    v_cvt_pk_bf16_f32 v81, v82, v83
    v_mfma_f32_16x16x32_bf16 v[36:39], v[96:99], v[240:243], v[36:39]
    v_exp_f32 v105, v105
    v_mfma_f32_16x16x32_bf16 v[60:63], v[100:103], v[232:235], v[60:63]
    ds_read_b128 v[228:231], v250 offset:59392
    v_exp_f32 v106, v106
    v_exp_f32 v107, v107
    v_mfma_f32_16x16x32_bf16 v[32:35], v[96:99], v[232:235], v[32:35]
    v_exp_f32 v92, v92
    s_waitcnt lgkmcnt(7)
    v_mfma_f32_16x16x32_bf16 v[56:59], v[100:103], v[196:199], v[56:59]
    v_exp_f32 v93, v93
    v_cvt_pk_bf16_f32 v86, v104, v105
    v_mfma_f32_16x16x32_bf16 v[44:47], v[96:99], v[196:199], v[44:47]
    ds_read_b128 v[232:235], v250 offset:60416
    v_exp_f32 v94, v94
    v_cvt_pk_bf16_f32 v87, v106, v107
    v_mfma_f32_16x16x32_bf16 v[52:55], v[100:103], v[200:203], v[52:55]
    v_exp_f32 v95, v95
    v_cvt_pk_bf16_f32 v82, v92, v93
    v_mfma_f32_16x16x32_bf16 v[40:43], v[96:99], v[200:203], v[40:43]
    ds_read_b128 v[196:199], v250 offset:28672
    v_cvt_pk_bf16_f32 v83, v94, v95
    s_waitcnt lgkmcnt(7)
    v_mfma_f32_16x16x32_bf16 v[28:31], v[84:87], v[204:207], v[28:31]
    v_exp_f32 v72, v72
    v_mfma_f32_16x16x32_bf16 v[12:15], v[80:83], v[204:207], v[12:15]
    ds_read_b128 v[200:203], v250 offset:29696
    v_mfma_f32_16x16x32_bf16 v[24:27], v[84:87], v[208:211], v[24:27]
    v_exp_f32 v73, v73
    v_mfma_f32_16x16x32_bf16 v[8:11], v[80:83], v[208:211], v[8:11]
    ds_read_b128 v[204:207], v250 offset:30720
    v_cvt_pk_bf16_f32 v72, v72, v73
    v_mfma_f32_16x16x32_bf16 v[36:39], v[84:87], v[236:239], v[36:39]
    s_waitcnt lgkmcnt(7)
    v_mfma_f32_16x16x32_bf16 v[20:23], v[84:87], v[212:215], v[20:23]
    ds_read_b128 v[208:211], v250 offset:31744
    v_exp_f32 v74, v74
    v_mfma_f32_16x16x32_bf16 v[4:7], v[80:83], v[212:215], v[4:7]
    v_exp_f32 v75, v75
    v_mfma_f32_16x16x32_bf16 v[16:19], v[84:87], v[216:219], v[16:19]
    v_exp_f32 v68, v68
    v_exp_f32 v69, v69
    v_mfma_f32_16x16x32_bf16 v[0:3], v[80:83], v[216:219], v[0:3]
    ds_read_b128 v[212:215], v250 offset:61440
    v_exp_f32 v70, v70
    s_waitcnt lgkmcnt(7)
    v_mfma_f32_16x16x32_bf16 v[64:67], v[84:87], v[220:223], v[64:67]
    v_exp_f32 v71, v71
    v_mfma_f32_16x16x32_bf16 v[48:51], v[80:83], v[220:223], v[48:51]
    ds_read_b128 v[216:219], v250 offset:62464
    v_exp_f32 v88, v88
    v_mfma_f32_16x16x32_bf16 v[36:39], v[80:83], v[240:243], v[36:39]
    v_exp_f32 v89, v89
    v_cvt_pk_bf16_f32 v73, v74, v75
    v_mfma_f32_16x16x32_bf16 v[60:63], v[84:87], v[224:227], v[60:63]
    ds_read_b128 v[220:223], v250 offset:63488
    v_exp_f32 v90, v90
    v_exp_f32 v91, v91
    v_cvt_pk_bf16_f32 v68, v68, v69
    v_mfma_f32_16x16x32_bf16 v[32:35], v[80:83], v[224:227], v[32:35]
    v_exp_f32 v76, v76
    s_waitcnt lgkmcnt(7)
    v_mfma_f32_16x16x32_bf16 v[56:59], v[84:87], v[228:231], v[56:59]
    v_exp_f32 v77, v77
    v_cvt_pk_bf16_f32 v69, v70, v71
    v_cvt_pk_bf16_f32 v74, v88, v89
    v_mfma_f32_16x16x32_bf16 v[44:47], v[80:83], v[228:231], v[44:47]
    ds_read_b128 v[224:227], v250 offset:64512
    v_exp_f32 v78, v78
    v_cvt_pk_bf16_f32 v75, v90, v91
    v_mfma_f32_16x16x32_bf16 v[52:55], v[84:87], v[232:235], v[52:55]
    v_exp_f32 v79, v79
    v_cvt_pk_bf16_f32 v70, v76, v77
    v_mfma_f32_16x16x32_bf16 v[40:43], v[80:83], v[232:235], v[40:43]
    ds_read_b128 v[228:231], v248 offset:0
    v_cvt_pk_bf16_f32 v71, v78, v79
    s_waitcnt lgkmcnt(7)
    v_mfma_f32_16x16x32_bf16 v[28:31], v[72:75], v[196:199], v[28:31]
    v_mfma_f32_16x16x32_bf16 v[12:15], v[68:71], v[196:199], v[12:15]
    ds_read_b128 v[232:235], v249 offset:1024
    v_mfma_f32_16x16x32_bf16 v[24:27], v[72:75], v[200:203], v[24:27]
    v_mfma_f32_16x16x32_bf16 v[8:11], v[68:71], v[200:203], v[8:11]
    ds_read_b128 v[196:199], v248 offset:2048
    v_mfma_f32_16x16x32_bf16 v[36:39], v[72:75], v[236:239], v[36:39]
    s_waitcnt lgkmcnt(7)
    v_mfma_f32_16x16x32_bf16 v[20:23], v[72:75], v[204:207], v[20:23]
    ds_read_b128 v[200:203], v249 offset:3072
    v_mfma_f32_16x16x32_bf16 v[4:7], v[68:71], v[204:207], v[4:7]
    v_mfma_f32_16x16x32_bf16 v[16:19], v[72:75], v[208:211], v[16:19]
    v_mfma_f32_16x16x32_bf16 v[0:3], v[68:71], v[208:211], v[0:3]
    ds_read_b128 v[204:207], v248 offset:4096
    s_waitcnt lgkmcnt(7)
    v_mfma_f32_16x16x32_bf16 v[64:67], v[72:75], v[212:215], v[64:67]
    v_mfma_f32_16x16x32_bf16 v[48:51], v[68:71], v[212:215], v[48:51]
    ds_read_b128 v[208:211], v249 offset:5120
    v_mfma_f32_16x16x32_bf16 v[36:39], v[68:71], v[240:243], v[36:39]
    v_mfma_f32_16x16x32_bf16 v[60:63], v[72:75], v[216:219], v[60:63]
    ds_read_b128 v[212:215], v248 offset:6144
    v_mfma_f32_16x16x32_bf16 v[32:35], v[68:71], v[216:219], v[32:35]
    s_waitcnt lgkmcnt(7)
    v_mfma_f32_16x16x32_bf16 v[56:59], v[72:75], v[220:223], v[56:59]
    v_mfma_f32_16x16x32_bf16 v[44:47], v[68:71], v[220:223], v[44:47]
    ds_read_b128 v[216:219], v249 offset:7168
    v_mfma_f32_16x16x32_bf16 v[52:55], v[72:75], v[224:227], v[52:55]
    v_rcp_f32 v36, v36
    v_mfma_f32_16x16x32_bf16 v[40:43], v[68:71], v[224:227], v[40:43]
    ds_read_b128 v[220:223], v248 offset:8192
    s_setprio 1
L_shared:
    buffer_load_dwordx4 v[140:143], v254, s[12:15], s34 offen offset:0
    buffer_load_dwordx4 v[128:131], v254, s[12:15], s34 offen offset:64
    buffer_load_dwordx4 v[136:139], v254, s[12:15], s35 offen offset:0
    buffer_load_dwordx4 v[124:127], v254, s[12:15], s35 offen offset:64
    buffer_load_dwordx4 v[120:123], v254, s[12:15], s34 offen offset:128
    buffer_load_dwordx4 v[112:115], v254, s[12:15], s34 offen offset:192
    buffer_load_dwordx4 v[116:119], v254, s[12:15], s35 offen offset:128
    buffer_load_dwordx4 v[108:111], v254, s[12:15], s35 offen offset:192
    v_rcp_f32 v37, v37
    v_rcp_f32 v38, v38
    v_rcp_f32 v39, v39
    v_mul_f32_dpp v28, v36, v28 quad_perm:[0,0,0,0] row_mask:0xf bank_mask:0xf
    v_mul_f32_dpp v29, v37, v29 quad_perm:[0,0,0,0] row_mask:0xf bank_mask:0xf
    v_mul_f32_dpp v30, v38, v30 quad_perm:[0,0,0,0] row_mask:0xf bank_mask:0xf
    v_mul_f32_dpp v31, v39, v31 quad_perm:[0,0,0,0] row_mask:0xf bank_mask:0xf
    v_mul_f32_dpp v24, v36, v24 quad_perm:[0,0,0,0] row_mask:0xf bank_mask:0xf
    v_mul_f32_dpp v25, v37, v25 quad_perm:[0,0,0,0] row_mask:0xf bank_mask:0xf
    v_mul_f32_dpp v26, v38, v26 quad_perm:[0,0,0,0] row_mask:0xf bank_mask:0xf
    v_mul_f32_dpp v27, v39, v27 quad_perm:[0,0,0,0] row_mask:0xf bank_mask:0xf
    v_cvt_pk_bf16_f32 v28, v28, v24
    v_cvt_pk_bf16_f32 v24, v29, v25
    v_mul_f32_dpp v20, v36, v20 quad_perm:[0,0,0,0] row_mask:0xf bank_mask:0xf
    v_mul_f32_dpp v21, v37, v21 quad_perm:[0,0,0,0] row_mask:0xf bank_mask:0xf
    v_mul_f32_dpp v22, v38, v22 quad_perm:[0,0,0,0] row_mask:0xf bank_mask:0xf
    v_mul_f32_dpp v23, v39, v23 quad_perm:[0,0,0,0] row_mask:0xf bank_mask:0xf
    v_mul_f32_dpp v16, v36, v16 quad_perm:[0,0,0,0] row_mask:0xf bank_mask:0xf
    v_mul_f32_dpp v17, v37, v17 quad_perm:[0,0,0,0] row_mask:0xf bank_mask:0xf
    v_mul_f32_dpp v18, v38, v18 quad_perm:[0,0,0,0] row_mask:0xf bank_mask:0xf
    v_mul_f32_dpp v19, v39, v19 quad_perm:[0,0,0,0] row_mask:0xf bank_mask:0xf
    v_cvt_pk_bf16_f32 v29, v20, v16
    v_cvt_pk_bf16_f32 v25, v21, v17
    v_cvt_pk_bf16_f32 v20, v30, v26
    v_cvt_pk_bf16_f32 v16, v31, v27
    v_cvt_pk_bf16_f32 v21, v22, v18
    v_cvt_pk_bf16_f32 v17, v23, v19
    v_mul_f32_dpp v64, v36, v64 quad_perm:[0,0,0,0] row_mask:0xf bank_mask:0xf
    v_mul_f32_dpp v65, v37, v65 quad_perm:[0,0,0,0] row_mask:0xf bank_mask:0xf
    v_mul_f32_dpp v66, v38, v66 quad_perm:[0,0,0,0] row_mask:0xf bank_mask:0xf
    v_mul_f32_dpp v67, v39, v67 quad_perm:[0,0,0,0] row_mask:0xf bank_mask:0xf
    v_mul_f32_dpp v60, v36, v60 quad_perm:[0,0,0,0] row_mask:0xf bank_mask:0xf
    v_mul_f32_dpp v61, v37, v61 quad_perm:[0,0,0,0] row_mask:0xf bank_mask:0xf
    v_mul_f32_dpp v62, v38, v62 quad_perm:[0,0,0,0] row_mask:0xf bank_mask:0xf
    v_mul_f32_dpp v63, v39, v63 quad_perm:[0,0,0,0] row_mask:0xf bank_mask:0xf
    v_cvt_pk_bf16_f32 v30, v64, v60
    v_cvt_pk_bf16_f32 v26, v65, v61
    v_cvt_pk_bf16_f32 v22, v66, v62
    v_cvt_pk_bf16_f32 v18, v67, v63
    v_mul_f32_dpp v56, v36, v56 quad_perm:[0,0,0,0] row_mask:0xf bank_mask:0xf
    v_mul_f32_dpp v57, v37, v57 quad_perm:[0,0,0,0] row_mask:0xf bank_mask:0xf
    v_mul_f32_dpp v58, v38, v58 quad_perm:[0,0,0,0] row_mask:0xf bank_mask:0xf
    v_mul_f32_dpp v59, v39, v59 quad_perm:[0,0,0,0] row_mask:0xf bank_mask:0xf
    v_mul_f32_dpp v52, v36, v52 quad_perm:[0,0,0,0] row_mask:0xf bank_mask:0xf
    v_mul_f32_dpp v53, v37, v53 quad_perm:[0,0,0,0] row_mask:0xf bank_mask:0xf
    v_mul_f32_dpp v54, v38, v54 quad_perm:[0,0,0,0] row_mask:0xf bank_mask:0xf
    v_mul_f32_dpp v55, v39, v55 quad_perm:[0,0,0,0] row_mask:0xf bank_mask:0xf
    v_cvt_pk_bf16_f32 v31, v56, v52
    v_cvt_pk_bf16_f32 v27, v57, v53
    v_cvt_pk_bf16_f32 v23, v58, v54
    v_cvt_pk_bf16_f32 v19, v59, v55
    v_mul_f32_dpp v12, v36, v12 quad_perm:[1,1,1,1] row_mask:0xf bank_mask:0xf
    v_mul_f32_dpp v13, v37, v13 quad_perm:[1,1,1,1] row_mask:0xf bank_mask:0xf
    v_mul_f32_dpp v14, v38, v14 quad_perm:[1,1,1,1] row_mask:0xf bank_mask:0xf
    v_mul_f32_dpp v15, v39, v15 quad_perm:[1,1,1,1] row_mask:0xf bank_mask:0xf
    v_mul_f32_dpp v8, v36, v8 quad_perm:[1,1,1,1] row_mask:0xf bank_mask:0xf
    v_mul_f32_dpp v9, v37, v9 quad_perm:[1,1,1,1] row_mask:0xf bank_mask:0xf
    v_mul_f32_dpp v10, v38, v10 quad_perm:[1,1,1,1] row_mask:0xf bank_mask:0xf
    v_mul_f32_dpp v11, v39, v11 quad_perm:[1,1,1,1] row_mask:0xf bank_mask:0xf
    v_cvt_pk_bf16_f32 v12, v12, v8
    v_cvt_pk_bf16_f32 v8, v13, v9
    v_mul_f32_dpp v4, v36, v4 quad_perm:[1,1,1,1] row_mask:0xf bank_mask:0xf
    v_mul_f32_dpp v5, v37, v5 quad_perm:[1,1,1,1] row_mask:0xf bank_mask:0xf
    v_mul_f32_dpp v6, v38, v6 quad_perm:[1,1,1,1] row_mask:0xf bank_mask:0xf
    v_mul_f32_dpp v7, v39, v7 quad_perm:[1,1,1,1] row_mask:0xf bank_mask:0xf
    v_mul_f32_dpp v0, v36, v0 quad_perm:[1,1,1,1] row_mask:0xf bank_mask:0xf
    v_mul_f32_dpp v1, v37, v1 quad_perm:[1,1,1,1] row_mask:0xf bank_mask:0xf
    v_mul_f32_dpp v2, v38, v2 quad_perm:[1,1,1,1] row_mask:0xf bank_mask:0xf
    v_mul_f32_dpp v3, v39, v3 quad_perm:[1,1,1,1] row_mask:0xf bank_mask:0xf
    v_cvt_pk_bf16_f32 v13, v4, v0
    v_cvt_pk_bf16_f32 v9, v5, v1
    v_cvt_pk_bf16_f32 v4, v14, v10
    v_cvt_pk_bf16_f32 v0, v15, v11
    v_cvt_pk_bf16_f32 v5, v6, v2
    v_cvt_pk_bf16_f32 v1, v7, v3
    v_mul_f32_dpp v48, v36, v48 quad_perm:[1,1,1,1] row_mask:0xf bank_mask:0xf
    v_mul_f32_dpp v49, v37, v49 quad_perm:[1,1,1,1] row_mask:0xf bank_mask:0xf
    v_mul_f32_dpp v50, v38, v50 quad_perm:[1,1,1,1] row_mask:0xf bank_mask:0xf
    v_mul_f32_dpp v51, v39, v51 quad_perm:[1,1,1,1] row_mask:0xf bank_mask:0xf
    v_mul_f32_dpp v32, v36, v32 quad_perm:[1,1,1,1] row_mask:0xf bank_mask:0xf
    v_mul_f32_dpp v33, v37, v33 quad_perm:[1,1,1,1] row_mask:0xf bank_mask:0xf
    v_mul_f32_dpp v34, v38, v34 quad_perm:[1,1,1,1] row_mask:0xf bank_mask:0xf
    v_mul_f32_dpp v35, v39, v35 quad_perm:[1,1,1,1] row_mask:0xf bank_mask:0xf
    v_cvt_pk_bf16_f32 v14, v48, v32
    v_cvt_pk_bf16_f32 v10, v49, v33
    v_cvt_pk_bf16_f32 v6, v50, v34
    v_cvt_pk_bf16_f32 v2, v51, v35
    v_mul_f32_dpp v44, v36, v44 quad_perm:[1,1,1,1] row_mask:0xf bank_mask:0xf
    v_mul_f32_dpp v45, v37, v45 quad_perm:[1,1,1,1] row_mask:0xf bank_mask:0xf
    v_mul_f32_dpp v46, v38, v46 quad_perm:[1,1,1,1] row_mask:0xf bank_mask:0xf
    v_mul_f32_dpp v47, v39, v47 quad_perm:[1,1,1,1] row_mask:0xf bank_mask:0xf
    v_mul_f32_dpp v40, v36, v40 quad_perm:[1,1,1,1] row_mask:0xf bank_mask:0xf
    v_mul_f32_dpp v41, v37, v41 quad_perm:[1,1,1,1] row_mask:0xf bank_mask:0xf
    v_mul_f32_dpp v42, v38, v42 quad_perm:[1,1,1,1] row_mask:0xf bank_mask:0xf
    v_mul_f32_dpp v43, v39, v43 quad_perm:[1,1,1,1] row_mask:0xf bank_mask:0xf
    v_cvt_pk_bf16_f32 v15, v44, v40
    v_cvt_pk_bf16_f32 v11, v45, v41
    v_cvt_pk_bf16_f32 v7, v46, v42
    v_cvt_pk_bf16_f32 v3, v47, v43
    v_max3_u32 v32, v36, v37, v38
    v_min3_u32 v33, v36, v37, v38
    v_max_u32 v32, v32, v39
    v_min_u32 v33, v33, v39
    v_cmp_le_u32_e64 s[40:41], s36, v32
    v_cmp_ge_u32_e64 s[44:45], s37, v33
    s_waitcnt vmcnt(7)
    ds_bpermute_b32 v140, v255, v140
    ds_bpermute_b32 v141, v255, v141
    ds_bpermute_b32 v142, v255, v142
    ds_bpermute_b32 v143, v255, v143
    s_waitcnt vmcnt(5)
    ds_bpermute_b32 v136, v255, v136
    ds_bpermute_b32 v137, v255, v137
    s_waitcnt lgkmcnt(7)
    ds_bpermute_b32 v138, v255, v138
    ds_bpermute_b32 v139, v255, v139
    ds_bpermute_b32 v128, v255, v128
    ds_bpermute_b32 v129, v255, v129
    ds_bpermute_b32 v130, v255, v130
    ds_bpermute_b32 v131, v255, v131
    s_waitcnt vmcnt(4)
    ds_bpermute_b32 v124, v255, v124
    ds_bpermute_b32 v125, v255, v125
    s_waitcnt lgkmcnt(7)
    ds_bpermute_b32 v126, v255, v126
    ds_bpermute_b32 v127, v255, v127
    s_waitcnt vmcnt(3)
    ds_bpermute_b32 v120, v255, v120
    ds_bpermute_b32 v121, v255, v121
    ds_bpermute_b32 v122, v255, v122
    ds_bpermute_b32 v123, v255, v123
    s_waitcnt vmcnt(1)
    ds_bpermute_b32 v116, v255, v116
    ds_bpermute_b32 v117, v255, v117
    s_waitcnt lgkmcnt(7)
    ds_bpermute_b32 v118, v255, v118
    ds_bpermute_b32 v119, v255, v119
    ds_bpermute_b32 v112, v255, v112
    ds_bpermute_b32 v113, v255, v113
    ds_bpermute_b32 v114, v255, v114
    ds_bpermute_b32 v115, v255, v115
    s_waitcnt vmcnt(0)
    ds_bpermute_b32 v108, v255, v108
    ds_bpermute_b32 v109, v255, v109
    s_waitcnt lgkmcnt(7)
    ds_bpermute_b32 v110, v255, v110
    ds_bpermute_b32 v111, v255, v111
    buffer_store_dwordx4 v[28:31], v252, s[24:27], s32 offen offset:0 sc1 nt
    buffer_store_dwordx4 v[24:27], v252, s[24:27], s32 offen offset:1024 sc1 nt
    buffer_store_dwordx4 v[20:23], v252, s[24:27], s32 offen offset:2048 sc1 nt
    buffer_store_dwordx4 v[16:19], v252, s[24:27], s32 offen offset:3072 sc1 nt
    buffer_store_dwordx4 v[12:15], v252, s[24:27], s33 offen offset:0 sc1 nt
    buffer_store_dwordx4 v[8:11], v252, s[24:27], s33 offen offset:1024 sc1 nt
    buffer_store_dwordx4 v[4:7], v252, s[24:27], s33 offen offset:2048 sc1 nt
    buffer_store_dwordx4 v[0:3], v252, s[24:27], s33 offen offset:3072 sc1 nt
    v_mfma_f32_16x16x32_bf16 v[144:147], v[228:231], v[140:143], v[244:247]
    v_mfma_f32_16x16x32_bf16 v[80:83], v[228:231], v[136:139], v[244:247]
    ds_read_b128 v[224:227], v249 offset:9216
    v_mfma_f32_16x16x32_bf16 v[144:147], v[232:235], v[128:131], v[144:147]
    v_mfma_f32_16x16x32_bf16 v[80:83], v[232:235], v[124:127], v[80:83]
    ds_read_b128 v[228:231], v248 offset:10240
    v_mfma_f32_16x16x32_bf16 v[144:147], v[196:199], v[120:123], v[144:147]
    s_waitcnt lgkmcnt(10)
    v_mfma_f32_16x16x32_bf16 v[80:83], v[196:199], v[116:119], v[80:83]
    ds_read_b128 v[232:235], v249 offset:11264
    s_waitcnt lgkmcnt(7)
    v_mfma_f32_16x16x32_bf16 v[144:147], v[200:203], v[112:115], v[144:147]
    s_waitcnt lgkmcnt(3)
    v_mfma_f32_16x16x32_bf16 v[80:83], v[200:203], v[108:111], v[80:83]
    ds_read_b128 v[196:199], v248 offset:12288
    v_mfma_f32_16x16x32_bf16 v[4:7], v[204:207], v[140:143], v[244:247]
    v_mfma_f32_16x16x32_bf16 v[0:3], v[204:207], v[136:139], v[244:247]
    ds_read_b128 v[200:203], v249 offset:13312
    v_mfma_f32_16x16x32_bf16 v[4:7], v[208:211], v[128:131], v[4:7]
    s_nop 0
    v_exp_f32 v144, v144
    v_mfma_f32_16x16x32_bf16 v[0:3], v[208:211], v[124:127], v[0:3]
    ds_read_b128 v[204:207], v248 offset:14336
    v_mfma_f32_16x16x32_bf16 v[4:7], v[212:215], v[120:123], v[4:7]
    v_exp_f32 v145, v145
    v_mfma_f32_16x16x32_bf16 v[0:3], v[212:215], v[116:119], v[0:3]
    ds_read_b128 v[208:211], v249 offset:15360
    v_cvt_pk_bf16_f32 v144, v144, v145
    v_mfma_f32_16x16x32_bf16 v[4:7], v[216:219], v[112:115], v[4:7]
    v_exp_f32 v146, v146
    v_mfma_f32_16x16x32_bf16 v[0:3], v[216:219], v[108:111], v[0:3]
    ds_read_b128 v[212:215], v248 offset:16384
    v_mfma_f32_16x16x32_bf16 v[96:99], v[220:223], v[140:143], v[244:247]
    v_exp_f32 v147, v147
    v_mfma_f32_16x16x32_bf16 v[76:79], v[220:223], v[136:139], v[244:247]
    ds_read_b128 v[216:219], v249 offset:17408
    s_waitcnt lgkmcnt(8)
    v_mfma_f32_16x16x32_bf16 v[96:99], v[224:227], v[128:131], v[96:99]
    v_exp_f32 v80, v80
    v_mfma_f32_16x16x32_bf16 v[76:79], v[224:227], v[124:127], v[76:79]
    ds_read_b128 v[220:223], v248 offset:18432
    s_waitcnt lgkmcnt(7)
    v_mfma_f32_16x16x32_bf16 v[96:99], v[228:231], v[120:123], v[96:99]
    v_exp_f32 v81, v81
    v_mfma_f32_16x16x32_bf16 v[76:79], v[228:231], v[116:119], v[76:79]
    ds_read_b128 v[224:227], v249 offset:19456
    v_cvt_pk_bf16_f32 v145, v146, v147
    v_mfma_f32_16x16x32_bf16 v[96:99], v[232:235], v[112:115], v[96:99]
    v_exp_f32 v82, v82
    v_mfma_f32_16x16x32_bf16 v[76:79], v[232:235], v[108:111], v[76:79]
    ds_read_b128 v[228:231], v248 offset:20480
    s_waitcnt lgkmcnt(7)
    v_mfma_f32_16x16x32_bf16 v[72:75], v[196:199], v[140:143], v[244:247]
    v_exp_f32 v83, v83
    v_mfma_f32_16x16x32_bf16 v[88:91], v[196:199], v[136:139], v[244:247]
    ds_read_b128 v[232:235], v249 offset:21504
    v_cvt_pk_bf16_f32 v80, v80, v81
    v_mfma_f32_16x16x32_bf16 v[72:75], v[200:203], v[128:131], v[72:75]
    v_exp_f32 v4, v4
    v_mfma_f32_16x16x32_bf16 v[88:91], v[200:203], v[124:127], v[88:91]
    ds_read_b128 v[196:199], v248 offset:22528
    s_waitcnt lgkmcnt(7)
    v_mfma_f32_16x16x32_bf16 v[72:75], v[204:207], v[120:123], v[72:75]
    v_exp_f32 v5, v5
    v_mfma_f32_16x16x32_bf16 v[88:91], v[204:207], v[116:119], v[88:91]
    ds_read_b128 v[200:203], v249 offset:23552
    v_cvt_pk_bf16_f32 v81, v82, v83
    v_mfma_f32_16x16x32_bf16 v[72:75], v[208:211], v[112:115], v[72:75]
    v_exp_f32 v6, v6
    v_mfma_f32_16x16x32_bf16 v[88:91], v[208:211], v[108:111], v[88:91]
    ds_read_b128 v[204:207], v250 offset:0
    s_waitcnt lgkmcnt(7)
    v_mfma_f32_16x16x32_bf16 v[132:135], v[212:215], v[140:143], v[244:247]
    v_exp_f32 v7, v7
    v_mfma_f32_16x16x32_bf16 v[84:87], v[212:215], v[136:139], v[244:247]
    ds_read_b128 v[208:211], v250 offset:1024
    v_cvt_pk_bf16_f32 v146, v4, v5
    v_mfma_f32_16x16x32_bf16 v[132:135], v[216:219], v[128:131], v[132:135]
    v_exp_f32 v0, v0
    v_mfma_f32_16x16x32_bf16 v[84:87], v[216:219], v[124:127], v[84:87]
    ds_read_b128 v[212:215], v250 offset:2048
    s_waitcnt lgkmcnt(7)
    v_mfma_f32_16x16x32_bf16 v[132:135], v[220:223], v[120:123], v[132:135]
    v_exp_f32 v1, v1
    v_mfma_f32_16x16x32_bf16 v[84:87], v[220:223], v[116:119], v[84:87]
    ds_read_b128 v[216:219], v250 offset:3072
    v_cvt_pk_bf16_f32 v147, v6, v7
    v_mfma_f32_16x16x32_bf16 v[132:135], v[224:227], v[112:115], v[132:135]
    v_exp_f32 v2, v2
    v_mfma_f32_16x16x32_bf16 v[84:87], v[224:227], v[108:111], v[84:87]
    ds_read_b128 v[220:223], v250 offset:32768
    s_waitcnt lgkmcnt(7)
    v_mfma_f32_16x16x32_bf16 v[60:63], v[228:231], v[140:143], v[244:247]
    v_exp_f32 v3, v3
    v_mfma_f32_16x16x32_bf16 v[92:95], v[228:231], v[136:139], v[244:247]
    ds_read_b128 v[224:227], v250 offset:33792
    v_cvt_pk_bf16_f32 v82, v0, v1
    v_mfma_f32_16x16x32_bf16 v[60:63], v[232:235], v[128:131], v[60:63]
    v_exp_f32 v96, v96
    v_mfma_f32_16x16x32_bf16 v[92:95], v[232:235], v[124:127], v[92:95]
    ds_read_b128 v[228:231], v250 offset:34816
    s_waitcnt lgkmcnt(7)
    v_mfma_f32_16x16x32_bf16 v[60:63], v[196:199], v[120:123], v[60:63]
    v_exp_f32 v97, v97
    v_mfma_f32_16x16x32_bf16 v[92:95], v[196:199], v[116:119], v[92:95]
    ds_read_b128 v[232:235], v250 offset:35840
    v_cvt_pk_bf16_f32 v83, v2, v3
    v_mfma_f32_16x16x32_bf16 v[60:63], v[200:203], v[112:115], v[60:63]
    v_exp_f32 v98, v98
    v_mfma_f32_16x16x32_bf16 v[92:95], v[200:203], v[108:111], v[92:95]
    ds_read_b128 v[196:199], v248 offset:24576
    s_waitcnt lgkmcnt(7)
    v_mfma_f32_16x16x32_bf16 v[56:59], v[144:147], v[204:207], 0
    v_exp_f32 v99, v99
    v_mfma_f32_16x16x32_bf16 v[28:31], v[80:83], v[204:207], 0
    ds_read_b128 v[200:203], v249 offset:25600
    v_cvt_pk_bf16_f32 v96, v96, v97
    v_mfma_f32_16x16x32_bf16 v[52:55], v[144:147], v[208:211], 0
    v_exp_f32 v76, v76
    v_mfma_f32_16x16x32_bf16 v[24:27], v[80:83], v[208:211], 0
    ds_read_b128 v[204:207], v248 offset:26624
    v_cvt_pk_bf16_f32 v97, v98, v99
    v_mfma_f32_16x16x32_bf16 v[4:7], v[144:147], v[236:239], 0
    s_waitcnt lgkmcnt(7)
    v_mfma_f32_16x16x32_bf16 v[40:43], v[144:147], v[212:215], 0
    ds_read_b128 v[208:211], v249 offset:27648
    v_mfma_f32_16x16x32_bf16 v[12:15], v[80:83], v[212:215], 0
    v_exp_f32 v77, v77
    v_mfma_f32_16x16x32_bf16 v[36:39], v[144:147], v[216:219], 0
    v_exp_f32 v78, v78
    v_mfma_f32_16x16x32_bf16 v[8:11], v[80:83], v[216:219], 0
    ds_read_b128 v[212:215], v248 offset:28672
    s_waitcnt lgkmcnt(7)
    v_mfma_f32_16x16x32_bf16 v[68:71], v[144:147], v[220:223], 0
    v_exp_f32 v79, v79
    v_mfma_f32_16x16x32_bf16 v[32:35], v[80:83], v[220:223], 0
    ds_read_b128 v[216:219], v249 offset:29696
    v_cvt_pk_bf16_f32 v76, v76, v77
    v_mfma_f32_16x16x32_bf16 v[4:7], v[80:83], v[240:243], v[4:7]
    v_exp_f32 v72, v72
    v_mfma_f32_16x16x32_bf16 v[64:67], v[144:147], v[224:227], 0
    ds_read_b128 v[220:223], v248 offset:30720
    v_cvt_pk_bf16_f32 v77, v78, v79
    v_mfma_f32_16x16x32_bf16 v[0:3], v[80:83], v[224:227], 0
    s_waitcnt lgkmcnt(7)
    v_mfma_f32_16x16x32_bf16 v[48:51], v[144:147], v[228:231], 0
    v_exp_f32 v73, v73
    v_mfma_f32_16x16x32_bf16 v[20:23], v[80:83], v[228:231], 0
    ds_read_b128 v[224:227], v249 offset:31744
    v_cvt_pk_bf16_f32 v98, v72, v73
    v_mfma_f32_16x16x32_bf16 v[44:47], v[144:147], v[232:235], 0
    v_exp_f32 v74, v74
    v_mfma_f32_16x16x32_bf16 v[16:19], v[80:83], v[232:235], 0
    ds_read_b128 v[228:231], v250 offset:4096
    s_waitcnt lgkmcnt(7)
    v_mfma_f32_16x16x32_bf16 v[104:107], v[196:199], v[140:143], v[244:247]
    v_exp_f32 v75, v75
    v_mfma_f32_16x16x32_bf16 v[100:103], v[196:199], v[136:139], v[244:247]
    ds_read_b128 v[232:235], v250 offset:5120
    v_cvt_pk_bf16_f32 v99, v74, v75
    v_mfma_f32_16x16x32_bf16 v[104:107], v[200:203], v[128:131], v[104:107]
    v_exp_f32 v88, v88
    v_mfma_f32_16x16x32_bf16 v[100:103], v[200:203], v[124:127], v[100:103]
    ds_read_b128 v[196:199], v250 offset:6144
    s_waitcnt lgkmcnt(7)
    v_mfma_f32_16x16x32_bf16 v[104:107], v[204:207], v[120:123], v[104:107]
    v_exp_f32 v89, v89
    v_mfma_f32_16x16x32_bf16 v[100:103], v[204:207], v[116:119], v[100:103]
    ds_read_b128 v[200:203], v250 offset:7168
    v_cvt_pk_bf16_f32 v78, v88, v89
    v_mfma_f32_16x16x32_bf16 v[104:107], v[208:211], v[112:115], v[104:107]
    v_exp_f32 v90, v90
    v_mfma_f32_16x16x32_bf16 v[100:103], v[208:211], v[108:111], v[100:103]
    ds_read_b128 v[204:207], v250 offset:36864
    s_waitcnt lgkmcnt(7)
    v_mfma_f32_16x16x32_bf16 v[80:83], v[212:215], v[140:143], v[244:247]
    v_exp_f32 v91, v91
    v_mfma_f32_16x16x32_bf16 v[72:75], v[212:215], v[136:139], v[244:247]
    ds_read_b128 v[208:211], v250 offset:37888
    v_cvt_pk_bf16_f32 v79, v90, v91
    v_mfma_f32_16x16x32_bf16 v[80:83], v[216:219], v[128:131], v[80:83]
    v_exp_f32 v132, v132
    v_mfma_f32_16x16x32_bf16 v[72:75], v[216:219], v[124:127], v[72:75]
    ds_read_b128 v[212:215], v250 offset:38912
    s_waitcnt lgkmcnt(7)
    v_mfma_f32_16x16x32_bf16 v[80:83], v[220:223], v[120:123], v[80:83]
    v_exp_f32 v133, v133
    v_mfma_f32_16x16x32_bf16 v[72:75], v[220:223], v[116:119], v[72:75]
    ds_read_b128 v[216:219], v250 offset:39936
    v_cvt_pk_bf16_f32 v132, v132, v133
    v_mfma_f32_16x16x32_bf16 v[80:83], v[224:227], v[112:115], v[80:83]
    v_exp_f32 v134, v134
    v_mfma_f32_16x16x32_bf16 v[72:75], v[224:227], v[108:111], v[72:75]
    ds_read_b128 v[220:223], v248 offset:32768
    s_waitcnt lgkmcnt(7)
    v_mfma_f32_16x16x32_bf16 v[56:59], v[96:99], v[228:231], v[56:59]
    v_exp_f32 v135, v135
    v_mfma_f32_16x16x32_bf16 v[28:31], v[76:79], v[228:231], v[28:31]
    ds_read_b128 v[224:227], v249 offset:33792
    v_cvt_pk_bf16_f32 v133, v134, v135
    v_mfma_f32_16x16x32_bf16 v[52:55], v[96:99], v[232:235], v[52:55]
    v_exp_f32 v84, v84
    v_mfma_f32_16x16x32_bf16 v[24:27], v[76:79], v[232:235], v[24:27]
    ds_read_b128 v[228:231], v248 offset:34816
    v_mfma_f32_16x16x32_bf16 v[4:7], v[96:99], v[236:239], v[4:7]
    s_waitcnt lgkmcnt(7)
    v_mfma_f32_16x16x32_bf16 v[40:43], v[96:99], v[196:199], v[40:43]
    ds_read_b128 v[232:235], v249 offset:35840
    v_mfma_f32_16x16x32_bf16 v[12:15], v[76:79], v[196:199], v[12:15]
    v_exp_f32 v85, v85
    v_mfma_f32_16x16x32_bf16 v[36:39], v[96:99], v[200:203], v[36:39]
    v_exp_f32 v86, v86
    v_mfma_f32_16x16x32_bf16 v[8:11], v[76:79], v[200:203], v[8:11]
    ds_read_b128 v[196:199], v248 offset:36864
    s_waitcnt lgkmcnt(7)
    v_mfma_f32_16x16x32_bf16 v[68:71], v[96:99], v[204:207], v[68:71]
    v_exp_f32 v87, v87
    v_mfma_f32_16x16x32_bf16 v[32:35], v[76:79], v[204:207], v[32:35]
    ds_read_b128 v[200:203], v249 offset:37888
    v_cvt_pk_bf16_f32 v84, v84, v85
    v_mfma_f32_16x16x32_bf16 v[4:7], v[76:79], v[240:243], v[4:7]
    v_exp_f32 v60, v60
    v_mfma_f32_16x16x32_bf16 v[64:67], v[96:99], v[208:211], v[64:67]
    ds_read_b128 v[204:207], v248 offset:38912
    v_cvt_pk_bf16_f32 v85, v86, v87
    v_mfma_f32_16x16x32_bf16 v[0:3], v[76:79], v[208:211], v[0:3]
    s_waitcnt lgkmcnt(7)
    v_mfma_f32_16x16x32_bf16 v[48:51], v[96:99], v[212:215], v[48:51]
    v_exp_f32 v61, v61
    v_mfma_f32_16x16x32_bf16 v[20:23], v[76:79], v[212:215], v[20:23]
    ds_read_b128 v[208:211], v249 offset:39936
    v_cvt_pk_bf16_f32 v134, v60, v61
    v_mfma_f32_16x16x32_bf16 v[44:47], v[96:99], v[216:219], v[44:47]
    v_exp_f32 v62, v62
    v_mfma_f32_16x16x32_bf16 v[16:19], v[76:79], v[216:219], v[16:19]
    ds_read_b128 v[212:215], v250 offset:8192
    s_waitcnt lgkmcnt(7)
    v_mfma_f32_16x16x32_bf16 v[144:147], v[220:223], v[140:143], v[244:247]
    v_exp_f32 v63, v63
    v_mfma_f32_16x16x32_bf16 v[88:91], v[220:223], v[136:139], v[244:247]
    ds_read_b128 v[216:219], v250 offset:9216
    v_cvt_pk_bf16_f32 v135, v62, v63
    v_mfma_f32_16x16x32_bf16 v[144:147], v[224:227], v[128:131], v[144:147]
    v_exp_f32 v92, v92
    v_mfma_f32_16x16x32_bf16 v[88:91], v[224:227], v[124:127], v[88:91]
    ds_read_b128 v[220:223], v250 offset:10240
    s_waitcnt lgkmcnt(7)
    v_mfma_f32_16x16x32_bf16 v[144:147], v[228:231], v[120:123], v[144:147]
    v_exp_f32 v93, v93
    v_mfma_f32_16x16x32_bf16 v[88:91], v[228:231], v[116:119], v[88:91]
    ds_read_b128 v[224:227], v250 offset:11264
    v_cvt_pk_bf16_f32 v86, v92, v93
    v_mfma_f32_16x16x32_bf16 v[144:147], v[232:235], v[112:115], v[144:147]
    v_exp_f32 v94, v94
    v_mfma_f32_16x16x32_bf16 v[88:91], v[232:235], v[108:111], v[88:91]
    ds_read_b128 v[228:231], v250 offset:40960
    s_waitcnt lgkmcnt(7)
    v_mfma_f32_16x16x32_bf16 v[76:79], v[196:199], v[140:143], v[244:247]
    v_exp_f32 v95, v95
    v_mfma_f32_16x16x32_bf16 v[60:63], v[196:199], v[136:139], v[244:247]
    ds_read_b128 v[232:235], v250 offset:41984
    v_cvt_pk_bf16_f32 v87, v94, v95
    v_mfma_f32_16x16x32_bf16 v[76:79], v[200:203], v[128:131], v[76:79]
    v_exp_f32 v104, v104
    v_mfma_f32_16x16x32_bf16 v[60:63], v[200:203], v[124:127], v[60:63]
    ds_read_b128 v[196:199], v250 offset:43008
    s_waitcnt lgkmcnt(7)
    v_mfma_f32_16x16x32_bf16 v[76:79], v[204:207], v[120:123], v[76:79]
    v_exp_f32 v105, v105
    v_mfma_f32_16x16x32_bf16 v[60:63], v[204:207], v[116:119], v[60:63]
    ds_read_b128 v[200:203], v250 offset:44032
    v_cvt_pk_bf16_f32 v104, v104, v105
    v_mfma_f32_16x16x32_bf16 v[76:79], v[208:211], v[112:115], v[76:79]
    v_exp_f32 v106, v106
    v_mfma_f32_16x16x32_bf16 v[60:63], v[208:211], v[108:111], v[60:63]
    ds_read_b128 v[204:207], v248 offset:40960
    s_waitcnt lgkmcnt(7)
    v_mfma_f32_16x16x32_bf16 v[56:59], v[132:135], v[212:215], v[56:59]
    v_exp_f32 v107, v107
    v_mfma_f32_16x16x32_bf16 v[28:31], v[84:87], v[212:215], v[28:31]
    ds_read_b128 v[208:211], v249 offset:41984
    v_cvt_pk_bf16_f32 v105, v106, v107
    v_mfma_f32_16x16x32_bf16 v[52:55], v[132:135], v[216:219], v[52:55]
    v_exp_f32 v100, v100
    v_mfma_f32_16x16x32_bf16 v[24:27], v[84:87], v[216:219], v[24:27]
    ds_read_b128 v[212:215], v248 offset:43008
    v_mfma_f32_16x16x32_bf16 v[4:7], v[132:135], v[236:239], v[4:7]
    s_waitcnt lgkmcnt(7)
    v_mfma_f32_16x16x32_bf16 v[40:43], v[132:135], v[220:223], v[40:43]
    ds_read_b128 v[216:219], v249 offset:44032
    v_mfma_f32_16x16x32_bf16 v[12:15], v[84:87], v[220:223], v[12:15]
    v_exp_f32 v101, v101
    v_mfma_f32_16x16x32_bf16 v[36:39], v[132:135], v[224:227], v[36:39]
    v_exp_f32 v102, v102
    v_mfma_f32_16x16x32_bf16 v[8:11], v[84:87], v[224:227], v[8:11]
    ds_read_b128 v[220:223], v248 offset:45056
    s_waitcnt lgkmcnt(7)
    v_mfma_f32_16x16x32_bf16 v[68:71], v[132:135], v[228:231], v[68:71]
    v_exp_f32 v103, v103
    v_mfma_f32_16x16x32_bf16 v[32:35], v[84:87], v[228:231], v[32:35]
    ds_read_b128 v[224:227], v249 offset:46080
    v_cvt_pk_bf16_f32 v100, v100, v101
    v_mfma_f32_16x16x32_bf16 v[4:7], v[84:87], v[240:243], v[4:7]
    v_exp_f32 v80, v80
    v_mfma_f32_16x16x32_bf16 v[64:67], v[132:135], v[232:235], v[64:67]
    ds_read_b128 v[228:231], v248 offset:47104
    v_cvt_pk_bf16_f32 v101, v102, v103
    v_mfma_f32_16x16x32_bf16 v[0:3], v[84:87], v[232:235], v[0:3]
    s_waitcnt lgkmcnt(7)
    v_mfma_f32_16x16x32_bf16 v[48:51], v[132:135], v[196:199], v[48:51]
    v_exp_f32 v81, v81
    v_mfma_f32_16x16x32_bf16 v[20:23], v[84:87], v[196:199], v[20:23]
    ds_read_b128 v[232:235], v249 offset:48128
    v_cvt_pk_bf16_f32 v106, v80, v81
    v_mfma_f32_16x16x32_bf16 v[44:47], v[132:135], v[200:203], v[44:47]
    v_exp_f32 v82, v82
    v_mfma_f32_16x16x32_bf16 v[16:19], v[84:87], v[200:203], v[16:19]
    ds_read_b128 v[196:199], v250 offset:12288
    s_waitcnt lgkmcnt(7)
    v_mfma_f32_16x16x32_bf16 v[96:99], v[204:207], v[140:143], v[244:247]
    v_exp_f32 v83, v83
    v_mfma_f32_16x16x32_bf16 v[92:95], v[204:207], v[136:139], v[244:247]
    ds_read_b128 v[200:203], v250 offset:13312
    v_cvt_pk_bf16_f32 v107, v82, v83
    v_mfma_f32_16x16x32_bf16 v[96:99], v[208:211], v[128:131], v[96:99]
    v_exp_f32 v72, v72
    v_mfma_f32_16x16x32_bf16 v[92:95], v[208:211], v[124:127], v[92:95]
    ds_read_b128 v[204:207], v250 offset:14336
    s_waitcnt lgkmcnt(7)
    v_mfma_f32_16x16x32_bf16 v[96:99], v[212:215], v[120:123], v[96:99]
    v_exp_f32 v73, v73
    v_mfma_f32_16x16x32_bf16 v[92:95], v[212:215], v[116:119], v[92:95]
    ds_read_b128 v[208:211], v250 offset:15360
    v_cvt_pk_bf16_f32 v102, v72, v73
    v_mfma_f32_16x16x32_bf16 v[96:99], v[216:219], v[112:115], v[96:99]
    v_exp_f32 v74, v74
    v_mfma_f32_16x16x32_bf16 v[92:95], v[216:219], v[108:111], v[92:95]
    ds_read_b128 v[212:215], v250 offset:45056
    s_waitcnt lgkmcnt(7)
    v_mfma_f32_16x16x32_bf16 v[84:87], v[220:223], v[140:143], v[244:247]
    v_exp_f32 v75, v75
    v_mfma_f32_16x16x32_bf16 v[132:135], v[220:223], v[136:139], v[244:247]
    ds_read_b128 v[216:219], v250 offset:46080
    v_cvt_pk_bf16_f32 v103, v74, v75
    v_mfma_f32_16x16x32_bf16 v[84:87], v[224:227], v[128:131], v[84:87]
    v_exp_f32 v144, v144
    v_mfma_f32_16x16x32_bf16 v[132:135], v[224:227], v[124:127], v[132:135]
    ds_read_b128 v[220:223], v250 offset:47104
    s_waitcnt lgkmcnt(7)
    v_mfma_f32_16x16x32_bf16 v[84:87], v[228:231], v[120:123], v[84:87]
    v_exp_f32 v145, v145
    v_mfma_f32_16x16x32_bf16 v[132:135], v[228:231], v[116:119], v[132:135]
    ds_read_b128 v[224:227], v250 offset:48128
    v_cvt_pk_bf16_f32 v144, v144, v145
    v_mfma_f32_16x16x32_bf16 v[84:87], v[232:235], v[112:115], v[84:87]
    v_exp_f32 v146, v146
    v_mfma_f32_16x16x32_bf16 v[132:135], v[232:235], v[108:111], v[132:135]
    ds_read_b128 v[228:231], v248 offset:49152
    s_waitcnt lgkmcnt(7)
    v_mfma_f32_16x16x32_bf16 v[56:59], v[104:107], v[196:199], v[56:59]
    v_exp_f32 v147, v147
    v_mfma_f32_16x16x32_bf16 v[28:31], v[100:103], v[196:199], v[28:31]
    ds_read_b128 v[232:235], v249 offset:50176
    v_cvt_pk_bf16_f32 v145, v146, v147
    v_mfma_f32_16x16x32_bf16 v[52:55], v[104:107], v[200:203], v[52:55]
    v_exp_f32 v88, v88
    v_mfma_f32_16x16x32_bf16 v[24:27], v[100:103], v[200:203], v[24:27]
    ds_read_b128 v[196:199], v248 offset:51200
    v_mfma_f32_16x16x32_bf16 v[4:7], v[104:107], v[236:239], v[4:7]
    s_waitcnt lgkmcnt(7)
    v_mfma_f32_16x16x32_bf16 v[40:43], v[104:107], v[204:207], v[40:43]
    ds_read_b128 v[200:203], v249 offset:52224
    v_mfma_f32_16x16x32_bf16 v[12:15], v[100:103], v[204:207], v[12:15]
    v_exp_f32 v89, v89
    v_mfma_f32_16x16x32_bf16 v[36:39], v[104:107], v[208:211], v[36:39]
    v_exp_f32 v90, v90
    v_mfma_f32_16x16x32_bf16 v[8:11], v[100:103], v[208:211], v[8:11]
    ds_read_b128 v[204:207], v248 offset:53248
    s_waitcnt lgkmcnt(7)
    v_mfma_f32_16x16x32_bf16 v[68:71], v[104:107], v[212:215], v[68:71]
    v_exp_f32 v91, v91
    v_mfma_f32_16x16x32_bf16 v[32:35], v[100:103], v[212:215], v[32:35]
    ds_read_b128 v[208:211], v249 offset:54272
    v_cvt_pk_bf16_f32 v88, v88, v89
    v_mfma_f32_16x16x32_bf16 v[4:7], v[100:103], v[240:243], v[4:7]
    v_exp_f32 v76, v76
    v_mfma_f32_16x16x32_bf16 v[64:67], v[104:107], v[216:219], v[64:67]
    ds_read_b128 v[212:215], v248 offset:55296
    v_cvt_pk_bf16_f32 v89, v90, v91
    v_mfma_f32_16x16x32_bf16 v[0:3], v[100:103], v[216:219], v[0:3]
    s_waitcnt lgkmcnt(7)
    v_mfma_f32_16x16x32_bf16 v[48:51], v[104:107], v[220:223], v[48:51]
    v_exp_f32 v77, v77
    v_mfma_f32_16x16x32_bf16 v[20:23], v[100:103], v[220:223], v[20:23]
    ds_read_b128 v[216:219], v249 offset:56320
    v_cvt_pk_bf16_f32 v146, v76, v77
    v_mfma_f32_16x16x32_bf16 v[44:47], v[104:107], v[224:227], v[44:47]
    v_exp_f32 v78, v78
    v_mfma_f32_16x16x32_bf16 v[16:19], v[100:103], v[224:227], v[16:19]
    ds_read_b128 v[220:223], v250 offset:16384
    s_waitcnt lgkmcnt(7)
    v_mfma_f32_16x16x32_bf16 v[80:83], v[228:231], v[140:143], v[244:247]
    v_exp_f32 v79, v79
    v_mfma_f32_16x16x32_bf16 v[72:75], v[228:231], v[136:139], v[244:247]
    ds_read_b128 v[224:227], v250 offset:17408
    v_cvt_pk_bf16_f32 v147, v78, v79
    v_mfma_f32_16x16x32_bf16 v[80:83], v[232:235], v[128:131], v[80:83]
    v_exp_f32 v60, v60
    v_mfma_f32_16x16x32_bf16 v[72:75], v[232:235], v[124:127], v[72:75]
    ds_read_b128 v[228:231], v250 offset:18432
    s_waitcnt lgkmcnt(7)
    v_mfma_f32_16x16x32_bf16 v[80:83], v[196:199], v[120:123], v[80:83]
    v_exp_f32 v61, v61
    v_mfma_f32_16x16x32_bf16 v[72:75], v[196:199], v[116:119], v[72:75]
    ds_read_b128 v[232:235], v250 offset:19456
    v_cvt_pk_bf16_f32 v90, v60, v61
    v_mfma_f32_16x16x32_bf16 v[80:83], v[200:203], v[112:115], v[80:83]
    v_exp_f32 v62, v62
    v_mfma_f32_16x16x32_bf16 v[72:75], v[200:203], v[108:111], v[72:75]
    ds_read_b128 v[196:199], v250 offset:49152
    s_waitcnt lgkmcnt(7)
    v_mfma_f32_16x16x32_bf16 v[104:107], v[204:207], v[140:143], v[244:247]
    v_exp_f32 v63, v63
    v_mfma_f32_16x16x32_bf16 v[100:103], v[204:207], v[136:139], v[244:247]
    ds_read_b128 v[200:203], v250 offset:50176
    v_cvt_pk_bf16_f32 v91, v62, v63
    v_mfma_f32_16x16x32_bf16 v[104:107], v[208:211], v[128:131], v[104:107]
    v_exp_f32 v96, v96
    v_mfma_f32_16x16x32_bf16 v[100:103], v[208:211], v[124:127], v[100:103]
    ds_read_b128 v[204:207], v250 offset:51200
    s_waitcnt lgkmcnt(7)
    v_mfma_f32_16x16x32_bf16 v[104:107], v[212:215], v[120:123], v[104:107]
    v_exp_f32 v97, v97
    v_mfma_f32_16x16x32_bf16 v[100:103], v[212:215], v[116:119], v[100:103]
    ds_read_b128 v[208:211], v250 offset:52224
    v_cvt_pk_bf16_f32 v96, v96, v97
    v_mfma_f32_16x16x32_bf16 v[104:107], v[216:219], v[112:115], v[104:107]
    v_exp_f32 v98, v98
    v_mfma_f32_16x16x32_bf16 v[100:103], v[216:219], v[108:111], v[100:103]
    ds_read_b128 v[212:215], v248 offset:57344
    s_waitcnt lgkmcnt(7)
    v_mfma_f32_16x16x32_bf16 v[56:59], v[144:147], v[220:223], v[56:59]
    v_exp_f32 v99, v99
    v_mfma_f32_16x16x32_bf16 v[28:31], v[88:91], v[220:223], v[28:31]
    ds_read_b128 v[216:219], v249 offset:58368
    v_cvt_pk_bf16_f32 v97, v98, v99
    v_mfma_f32_16x16x32_bf16 v[52:55], v[144:147], v[224:227], v[52:55]
    v_exp_f32 v92, v92
    v_mfma_f32_16x16x32_bf16 v[24:27], v[88:91], v[224:227], v[24:27]
    ds_read_b128 v[220:223], v248 offset:59392
    v_mfma_f32_16x16x32_bf16 v[4:7], v[144:147], v[236:239], v[4:7]
    s_waitcnt lgkmcnt(7)
    v_mfma_f32_16x16x32_bf16 v[40:43], v[144:147], v[228:231], v[40:43]
    ds_read_b128 v[224:227], v249 offset:60416
    v_mfma_f32_16x16x32_bf16 v[12:15], v[88:91], v[228:231], v[12:15]
    v_exp_f32 v93, v93
    v_mfma_f32_16x16x32_bf16 v[36:39], v[144:147], v[232:235], v[36:39]
    v_exp_f32 v94, v94
    v_mfma_f32_16x16x32_bf16 v[8:11], v[88:91], v[232:235], v[8:11]
    ds_read_b128 v[228:231], v248 offset:61440
    s_waitcnt lgkmcnt(7)
    v_mfma_f32_16x16x32_bf16 v[68:71], v[144:147], v[196:199], v[68:71]
    v_exp_f32 v95, v95
    v_mfma_f32_16x16x32_bf16 v[32:35], v[88:91], v[196:199], v[32:35]
    ds_read_b128 v[232:235], v249 offset:62464
    v_cvt_pk_bf16_f32 v92, v92, v93
    v_mfma_f32_16x16x32_bf16 v[4:7], v[88:91], v[240:243], v[4:7]
    v_exp_f32 v84, v84
    v_mfma_f32_16x16x32_bf16 v[64:67], v[144:147], v[200:203], v[64:67]
    ds_read_b128 v[196:199], v248 offset:63488
    v_cvt_pk_bf16_f32 v93, v94, v95
    v_mfma_f32_16x16x32_bf16 v[0:3], v[88:91], v[200:203], v[0:3]
    s_waitcnt lgkmcnt(7)
    v_mfma_f32_16x16x32_bf16 v[48:51], v[144:147], v[204:207], v[48:51]
    v_exp_f32 v85, v85
    v_mfma_f32_16x16x32_bf16 v[20:23], v[88:91], v[204:207], v[20:23]
    ds_read_b128 v[200:203], v249 offset:64512
    v_cvt_pk_bf16_f32 v98, v84, v85
    v_mfma_f32_16x16x32_bf16 v[44:47], v[144:147], v[208:211], v[44:47]
    v_exp_f32 v86, v86
    v_mfma_f32_16x16x32_bf16 v[16:19], v[88:91], v[208:211], v[16:19]
    ds_read_b128 v[204:207], v250 offset:20480
    s_waitcnt lgkmcnt(7)
    v_mfma_f32_16x16x32_bf16 v[76:79], v[212:215], v[140:143], v[244:247]
    v_exp_f32 v87, v87
    v_mfma_f32_16x16x32_bf16 v[60:63], v[212:215], v[136:139], v[244:247]
    ds_read_b128 v[208:211], v250 offset:21504
    v_cvt_pk_bf16_f32 v99, v86, v87
    v_mfma_f32_16x16x32_bf16 v[76:79], v[216:219], v[128:131], v[76:79]
    v_exp_f32 v132, v132
    v_mfma_f32_16x16x32_bf16 v[60:63], v[216:219], v[124:127], v[60:63]
    ds_read_b128 v[212:215], v250 offset:22528
    s_waitcnt lgkmcnt(7)
    v_mfma_f32_16x16x32_bf16 v[76:79], v[220:223], v[120:123], v[76:79]
    v_exp_f32 v133, v133
    v_mfma_f32_16x16x32_bf16 v[60:63], v[220:223], v[116:119], v[60:63]
    ds_read_b128 v[216:219], v250 offset:23552
    v_cvt_pk_bf16_f32 v94, v132, v133
    v_mfma_f32_16x16x32_bf16 v[76:79], v[224:227], v[112:115], v[76:79]
    v_exp_f32 v134, v134
    v_mfma_f32_16x16x32_bf16 v[60:63], v[224:227], v[108:111], v[60:63]
    ds_read_b128 v[220:223], v250 offset:53248
    s_waitcnt lgkmcnt(7)
    v_mfma_f32_16x16x32_bf16 v[88:91], v[228:231], v[140:143], v[244:247]
    v_exp_f32 v135, v135
    v_mfma_f32_16x16x32_bf16 v[84:87], v[228:231], v[136:139], v[244:247]
    ds_read_b128 v[224:227], v250 offset:54272
    v_cvt_pk_bf16_f32 v95, v134, v135
    v_mfma_f32_16x16x32_bf16 v[88:91], v[232:235], v[128:131], v[88:91]
    v_exp_f32 v80, v80
    v_mfma_f32_16x16x32_bf16 v[84:87], v[232:235], v[124:127], v[84:87]
    ds_read_b128 v[228:231], v250 offset:55296
    s_waitcnt lgkmcnt(7)
    v_mfma_f32_16x16x32_bf16 v[88:91], v[196:199], v[120:123], v[88:91]
    v_exp_f32 v81, v81
    v_mfma_f32_16x16x32_bf16 v[84:87], v[196:199], v[116:119], v[84:87]
    ds_read_b128 v[232:235], v250 offset:56320
    v_exp_f32 v82, v82
    v_mfma_f32_16x16x32_bf16 v[88:91], v[200:203], v[112:115], v[88:91]
    v_exp_f32 v83, v83
    v_mfma_f32_16x16x32_bf16 v[84:87], v[200:203], v[108:111], v[84:87]
    ds_read_b128 v[196:199], v250 offset:24576
    v_exp_f32 v72, v72
    v_exp_f32 v73, v73
    s_waitcnt lgkmcnt(7)
    v_mfma_f32_16x16x32_bf16 v[56:59], v[96:99], v[204:207], v[56:59]
    v_exp_f32 v74, v74
    v_mfma_f32_16x16x32_bf16 v[28:31], v[92:95], v[204:207], v[28:31]
    ds_read_b128 v[200:203], v250 offset:28672
    v_exp_f32 v75, v75
    v_cvt_pk_bf16_f32 v80, v80, v81
    v_mfma_f32_16x16x32_bf16 v[52:55], v[96:99], v[208:211], v[52:55]
    v_exp_f32 v104, v104
    v_mfma_f32_16x16x32_bf16 v[24:27], v[92:95], v[208:211], v[24:27]
    ds_read_b128 v[204:207], v250 offset:25600
    v_exp_f32 v105, v105
    v_exp_f32 v106, v106
    v_cvt_pk_bf16_f32 v81, v82, v83
    v_mfma_f32_16x16x32_bf16 v[4:7], v[96:99], v[236:239], v[4:7]
    v_exp_f32 v107, v107
    v_cvt_pk_bf16_f32 v72, v72, v73
    s_waitcnt lgkmcnt(7)
    v_mfma_f32_16x16x32_bf16 v[40:43], v[96:99], v[212:215], v[40:43]
    ds_read_b128 v[208:211], v250 offset:29696
    v_exp_f32 v100, v100
    v_mfma_f32_16x16x32_bf16 v[12:15], v[92:95], v[212:215], v[12:15]
    v_exp_f32 v101, v101
    v_cvt_pk_bf16_f32 v73, v74, v75
    v_mfma_f32_16x16x32_bf16 v[36:39], v[96:99], v[216:219], v[36:39]
    v_exp_f32 v102, v102
    v_mfma_f32_16x16x32_bf16 v[8:11], v[92:95], v[216:219], v[8:11]
    ds_read_b128 v[212:215], v250 offset:26624
    v_exp_f32 v103, v103
    v_exp_f32 v76, v76
    v_cvt_pk_bf16_f32 v82, v104, v105
    s_waitcnt lgkmcnt(7)
    v_mfma_f32_16x16x32_bf16 v[68:71], v[96:99], v[220:223], v[68:71]
    v_exp_f32 v77, v77
    v_cvt_pk_bf16_f32 v83, v106, v107
    v_mfma_f32_16x16x32_bf16 v[32:35], v[92:95], v[220:223], v[32:35]
    ds_read_b128 v[216:219], v250 offset:30720
    v_exp_f32 v78, v78
    v_mfma_f32_16x16x32_bf16 v[4:7], v[92:95], v[240:243], v[4:7]
    v_exp_f32 v79, v79
    v_cvt_pk_bf16_f32 v74, v100, v101
    v_mfma_f32_16x16x32_bf16 v[64:67], v[96:99], v[224:227], v[64:67]
    ds_read_b128 v[220:223], v250 offset:27648
    v_exp_f32 v60, v60
    v_exp_f32 v61, v61
    v_cvt_pk_bf16_f32 v75, v102, v103
    v_mfma_f32_16x16x32_bf16 v[0:3], v[92:95], v[224:227], v[0:3]
    v_exp_f32 v62, v62
    s_waitcnt lgkmcnt(7)
    v_mfma_f32_16x16x32_bf16 v[48:51], v[96:99], v[228:231], v[48:51]
    v_exp_f32 v63, v63
    v_cvt_pk_bf16_f32 v76, v76, v77
    v_mfma_f32_16x16x32_bf16 v[20:23], v[92:95], v[228:231], v[20:23]
    ds_read_b128 v[224:227], v250 offset:31744
    v_exp_f32 v88, v88
    v_mfma_f32_16x16x32_bf16 v[44:47], v[96:99], v[232:235], v[44:47]
    v_exp_f32 v89, v89
    v_cvt_pk_bf16_f32 v77, v78, v79
    v_mfma_f32_16x16x32_bf16 v[16:19], v[92:95], v[232:235], v[16:19]
    ds_read_b128 v[228:231], v250 offset:57344
    v_exp_f32 v90, v90
    v_exp_f32 v91, v91
    v_cvt_pk_bf16_f32 v60, v60, v61
    s_waitcnt lgkmcnt(7)
    v_mfma_f32_16x16x32_bf16 v[56:59], v[80:83], v[196:199], v[56:59]
    v_exp_f32 v84, v84
    v_cvt_pk_bf16_f32 v61, v62, v63
    v_mfma_f32_16x16x32_bf16 v[4:7], v[80:83], v[236:239], v[4:7]
    ds_read_b128 v[232:235], v250 offset:61440
    v_exp_f32 v85, v85
    v_cvt_pk_bf16_f32 v78, v88, v89
    v_cvt_pk_bf16_f32 v79, v90, v91
    v_mfma_f32_16x16x32_bf16 v[28:31], v[72:75], v[196:199], v[28:31]
    v_exp_f32 v86, v86
    v_mfma_f32_16x16x32_bf16 v[4:7], v[72:75], v[240:243], v[4:7]
    v_exp_f32 v87, v87
    v_cvt_pk_bf16_f32 v62, v84, v85
    v_mfma_f32_16x16x32_bf16 v[56:59], v[76:79], v[200:203], v[56:59]
    ds_read_b128 v[196:199], v250 offset:58368
    v_cvt_pk_bf16_f32 v63, v86, v87
    v_mfma_f32_16x16x32_bf16 v[4:7], v[76:79], v[236:239], v[4:7]
    s_nop 0
    v_mfma_f32_16x16x32_bf16 v[28:31], v[60:63], v[200:203], v[28:31]
    v_mfma_f32_16x16x32_bf16 v[4:7], v[60:63], v[240:243], v[4:7]
    s_waitcnt lgkmcnt(7)
    v_mfma_f32_16x16x32_bf16 v[52:55], v[80:83], v[204:207], v[52:55]
    ds_read_b128 v[200:203], v250 offset:62464
    v_mfma_f32_16x16x32_bf16 v[24:27], v[72:75], v[204:207], v[24:27]
    v_mfma_f32_16x16x32_bf16 v[52:55], v[76:79], v[208:211], v[52:55]
    v_mfma_f32_16x16x32_bf16 v[24:27], v[60:63], v[208:211], v[24:27]
    ds_read_b128 v[204:207], v250 offset:59392
    s_waitcnt lgkmcnt(7)
    v_mfma_f32_16x16x32_bf16 v[40:43], v[80:83], v[212:215], v[40:43]
    v_rcp_f32 v4, v4
    v_mfma_f32_16x16x32_bf16 v[12:15], v[72:75], v[212:215], v[12:15]
    ds_read_b128 v[208:211], v250 offset:63488
    v_rcp_f32 v5, v5
    v_mfma_f32_16x16x32_bf16 v[40:43], v[76:79], v[216:219], v[40:43]
    v_rcp_f32 v6, v6
    v_mfma_f32_16x16x32_bf16 v[12:15], v[60:63], v[216:219], v[12:15]
    ds_read_b128 v[212:215], v250 offset:60416
    s_waitcnt lgkmcnt(7)
    v_mfma_f32_16x16x32_bf16 v[36:39], v[80:83], v[220:223], v[36:39]
    v_rcp_f32 v7, v7
    v_mfma_f32_16x16x32_bf16 v[8:11], v[72:75], v[220:223], v[8:11]
    ds_read_b128 v[216:219], v250 offset:64512
    v_mul_f32_dpp v56, v4, v56 quad_perm:[0,0,0,0] row_mask:0xf bank_mask:0xf
    v_mul_f32_dpp v57, v5, v57 quad_perm:[0,0,0,0] row_mask:0xf bank_mask:0xf
    v_mfma_f32_16x16x32_bf16 v[36:39], v[76:79], v[224:227], v[36:39]
    v_mul_f32_dpp v58, v6, v58 quad_perm:[0,0,0,0] row_mask:0xf bank_mask:0xf
    v_mul_f32_dpp v59, v7, v59 quad_perm:[0,0,0,0] row_mask:0xf bank_mask:0xf
    v_mul_f32_dpp v52, v4, v52 quad_perm:[0,0,0,0] row_mask:0xf bank_mask:0xf
    v_mfma_f32_16x16x32_bf16 v[8:11], v[60:63], v[224:227], v[8:11]
    v_mul_f32_dpp v53, v5, v53 quad_perm:[0,0,0,0] row_mask:0xf bank_mask:0xf
    v_mul_f32_dpp v54, v6, v54 quad_perm:[0,0,0,0] row_mask:0xf bank_mask:0xf
    s_waitcnt lgkmcnt(6)
    v_mfma_f32_16x16x32_bf16 v[68:71], v[80:83], v[228:231], v[68:71]
    v_mul_f32_dpp v55, v7, v55 quad_perm:[0,0,0,0] row_mask:0xf bank_mask:0xf
    v_cvt_pk_bf16_f32 v56, v56, v52
    v_mul_f32_dpp v28, v4, v28 quad_perm:[1,1,1,1] row_mask:0xf bank_mask:0xf
    v_mfma_f32_16x16x32_bf16 v[32:35], v[72:75], v[228:231], v[32:35]
    v_cvt_pk_bf16_f32 v52, v57, v53
    v_mul_f32_dpp v40, v4, v40 quad_perm:[0,0,0,0] row_mask:0xf bank_mask:0xf
    v_mul_f32_dpp v41, v5, v41 quad_perm:[0,0,0,0] row_mask:0xf bank_mask:0xf
    v_mfma_f32_16x16x32_bf16 v[68:71], v[76:79], v[232:235], v[68:71]
    v_mul_f32_dpp v42, v6, v42 quad_perm:[0,0,0,0] row_mask:0xf bank_mask:0xf
    v_mul_f32_dpp v43, v7, v43 quad_perm:[0,0,0,0] row_mask:0xf bank_mask:0xf
    v_mul_f32_dpp v29, v5, v29 quad_perm:[1,1,1,1] row_mask:0xf bank_mask:0xf
    v_mfma_f32_16x16x32_bf16 v[32:35], v[60:63], v[232:235], v[32:35]
    v_mul_f32_dpp v36, v4, v36 quad_perm:[0,0,0,0] row_mask:0xf bank_mask:0xf
    v_mul_f32_dpp v37, v5, v37 quad_perm:[0,0,0,0] row_mask:0xf bank_mask:0xf
    s_waitcnt lgkmcnt(4)
    v_mfma_f32_16x16x32_bf16 v[64:67], v[80:83], v[196:199], v[64:67]
    v_mul_f32_dpp v38, v6, v38 quad_perm:[0,0,0,0] row_mask:0xf bank_mask:0xf
    v_mul_f32_dpp v39, v7, v39 quad_perm:[0,0,0,0] row_mask:0xf bank_mask:0xf
    v_cvt_pk_bf16_f32 v57, v40, v36
    v_mfma_f32_16x16x32_bf16 v[0:3], v[72:75], v[196:199], v[0:3]
    v_cvt_pk_bf16_f32 v53, v41, v37
    v_cvt_pk_bf16_f32 v40, v58, v54
    v_mfma_f32_16x16x32_bf16 v[64:67], v[76:79], v[200:203], v[64:67]
    v_cvt_pk_bf16_f32 v36, v59, v55
    v_cvt_pk_bf16_f32 v41, v42, v38
    v_mfma_f32_16x16x32_bf16 v[0:3], v[60:63], v[200:203], v[0:3]
    v_cvt_pk_bf16_f32 v37, v43, v39
    v_mul_f32_dpp v68, v4, v68 quad_perm:[0,0,0,0] row_mask:0xf bank_mask:0xf
    s_waitcnt lgkmcnt(2)
    v_mfma_f32_16x16x32_bf16 v[48:51], v[80:83], v[204:207], v[48:51]
    v_mul_f32_dpp v69, v5, v69 quad_perm:[0,0,0,0] row_mask:0xf bank_mask:0xf
    v_mul_f32_dpp v70, v6, v70 quad_perm:[0,0,0,0] row_mask:0xf bank_mask:0xf
    v_mul_f32_dpp v71, v7, v71 quad_perm:[0,0,0,0] row_mask:0xf bank_mask:0xf
    v_mfma_f32_16x16x32_bf16 v[20:23], v[72:75], v[204:207], v[20:23]
    v_mul_f32_dpp v30, v6, v30 quad_perm:[1,1,1,1] row_mask:0xf bank_mask:0xf
    v_mul_f32_dpp v31, v7, v31 quad_perm:[1,1,1,1] row_mask:0xf bank_mask:0xf
    v_mul_f32_dpp v24, v4, v24 quad_perm:[1,1,1,1] row_mask:0xf bank_mask:0xf
    v_mfma_f32_16x16x32_bf16 v[48:51], v[76:79], v[208:211], v[48:51]
    v_mul_f32_dpp v25, v5, v25 quad_perm:[1,1,1,1] row_mask:0xf bank_mask:0xf
    v_mul_f32_dpp v26, v6, v26 quad_perm:[1,1,1,1] row_mask:0xf bank_mask:0xf
    v_mul_f32_dpp v27, v7, v27 quad_perm:[1,1,1,1] row_mask:0xf bank_mask:0xf
    v_mfma_f32_16x16x32_bf16 v[20:23], v[60:63], v[208:211], v[20:23]
    v_mul_f32_dpp v64, v4, v64 quad_perm:[0,0,0,0] row_mask:0xf bank_mask:0xf
    v_mul_f32_dpp v65, v5, v65 quad_perm:[0,0,0,0] row_mask:0xf bank_mask:0xf
    s_waitcnt lgkmcnt(0)
    v_mfma_f32_16x16x32_bf16 v[44:47], v[80:83], v[212:215], v[44:47]
    v_mul_f32_dpp v66, v6, v66 quad_perm:[0,0,0,0] row_mask:0xf bank_mask:0xf
    v_mul_f32_dpp v67, v7, v67 quad_perm:[0,0,0,0] row_mask:0xf bank_mask:0xf
    v_cvt_pk_bf16_f32 v58, v68, v64
    v_mfma_f32_16x16x32_bf16 v[44:47], v[76:79], v[216:219], v[44:47]
    v_cvt_pk_bf16_f32 v54, v69, v65
    v_cvt_pk_bf16_f32 v42, v70, v66
    v_mfma_f32_16x16x32_bf16 v[16:19], v[72:75], v[212:215], v[16:19]
    v_cvt_pk_bf16_f32 v38, v71, v67
    v_cvt_pk_bf16_f32 v28, v28, v24
    v_mfma_f32_16x16x32_bf16 v[16:19], v[60:63], v[216:219], v[16:19]
    v_mul_f32_dpp v48, v4, v48 quad_perm:[0,0,0,0] row_mask:0xf bank_mask:0xf
    v_mul_f32_dpp v49, v5, v49 quad_perm:[0,0,0,0] row_mask:0xf bank_mask:0xf
    v_mul_f32_dpp v50, v6, v50 quad_perm:[0,0,0,0] row_mask:0xf bank_mask:0xf
    s_setprio 0
    v_mul_f32_dpp v51, v7, v51 quad_perm:[0,0,0,0] row_mask:0xf bank_mask:0xf
    v_mul_f32_dpp v44, v4, v44 quad_perm:[0,0,0,0] row_mask:0xf bank_mask:0xf
    v_mul_f32_dpp v45, v5, v45 quad_perm:[0,0,0,0] row_mask:0xf bank_mask:0xf
    v_mul_f32_dpp v46, v6, v46 quad_perm:[0,0,0,0] row_mask:0xf bank_mask:0xf
    v_mul_f32_dpp v47, v7, v47 quad_perm:[0,0,0,0] row_mask:0xf bank_mask:0xf
    v_cvt_pk_bf16_f32 v59, v48, v44
    v_cvt_pk_bf16_f32 v55, v49, v45
    buffer_store_dwordx4 v[56:59], v252, s[24:27], s34 offen offset:0 sc1 nt
    v_cvt_pk_bf16_f32 v43, v50, v46
    buffer_store_dwordx4 v[52:55], v252, s[24:27], s34 offen offset:1024 sc1 nt
    v_cvt_pk_bf16_f32 v39, v51, v47
    buffer_store_dwordx4 v[40:43], v252, s[24:27], s34 offen offset:2048 sc1 nt
    v_cvt_pk_bf16_f32 v24, v29, v25
    buffer_store_dwordx4 v[36:39], v252, s[24:27], s34 offen offset:3072 sc1 nt
    v_mul_f32_dpp v12, v4, v12 quad_perm:[1,1,1,1] row_mask:0xf bank_mask:0xf
    v_mul_f32_dpp v13, v5, v13 quad_perm:[1,1,1,1] row_mask:0xf bank_mask:0xf
    v_mul_f32_dpp v14, v6, v14 quad_perm:[1,1,1,1] row_mask:0xf bank_mask:0xf
    v_mul_f32_dpp v15, v7, v15 quad_perm:[1,1,1,1] row_mask:0xf bank_mask:0xf
    v_mul_f32_dpp v8, v4, v8 quad_perm:[1,1,1,1] row_mask:0xf bank_mask:0xf
    v_mul_f32_dpp v9, v5, v9 quad_perm:[1,1,1,1] row_mask:0xf bank_mask:0xf
    v_mul_f32_dpp v10, v6, v10 quad_perm:[1,1,1,1] row_mask:0xf bank_mask:0xf
    v_mul_f32_dpp v11, v7, v11 quad_perm:[1,1,1,1] row_mask:0xf bank_mask:0xf
    v_cvt_pk_bf16_f32 v29, v12, v8
    v_cvt_pk_bf16_f32 v25, v13, v9
    v_cvt_pk_bf16_f32 v12, v30, v26
    v_cvt_pk_bf16_f32 v8, v31, v27
    v_cvt_pk_bf16_f32 v13, v14, v10
    v_cvt_pk_bf16_f32 v9, v15, v11
    v_mul_f32_dpp v32, v4, v32 quad_perm:[1,1,1,1] row_mask:0xf bank_mask:0xf
    v_mul_f32_dpp v33, v5, v33 quad_perm:[1,1,1,1] row_mask:0xf bank_mask:0xf
    v_mul_f32_dpp v34, v6, v34 quad_perm:[1,1,1,1] row_mask:0xf bank_mask:0xf
    v_mul_f32_dpp v35, v7, v35 quad_perm:[1,1,1,1] row_mask:0xf bank_mask:0xf
    v_mul_f32_dpp v0, v4, v0 quad_perm:[1,1,1,1] row_mask:0xf bank_mask:0xf
    v_mul_f32_dpp v1, v5, v1 quad_perm:[1,1,1,1] row_mask:0xf bank_mask:0xf
    v_mul_f32_dpp v2, v6, v2 quad_perm:[1,1,1,1] row_mask:0xf bank_mask:0xf
    v_mul_f32_dpp v3, v7, v3 quad_perm:[1,1,1,1] row_mask:0xf bank_mask:0xf
    v_cvt_pk_bf16_f32 v30, v32, v0
    v_cvt_pk_bf16_f32 v26, v33, v1
    v_cvt_pk_bf16_f32 v14, v34, v2
    v_cvt_pk_bf16_f32 v10, v35, v3
    v_mul_f32_dpp v20, v4, v20 quad_perm:[1,1,1,1] row_mask:0xf bank_mask:0xf
    v_mul_f32_dpp v21, v5, v21 quad_perm:[1,1,1,1] row_mask:0xf bank_mask:0xf
    v_mul_f32_dpp v22, v6, v22 quad_perm:[1,1,1,1] row_mask:0xf bank_mask:0xf
    v_mul_f32_dpp v23, v7, v23 quad_perm:[1,1,1,1] row_mask:0xf bank_mask:0xf
    v_mul_f32_dpp v16, v4, v16 quad_perm:[1,1,1,1] row_mask:0xf bank_mask:0xf
    v_mul_f32_dpp v17, v5, v17 quad_perm:[1,1,1,1] row_mask:0xf bank_mask:0xf
    v_mul_f32_dpp v18, v6, v18 quad_perm:[1,1,1,1] row_mask:0xf bank_mask:0xf
    v_mul_f32_dpp v19, v7, v19 quad_perm:[1,1,1,1] row_mask:0xf bank_mask:0xf
    v_cvt_pk_bf16_f32 v31, v20, v16
    v_cvt_pk_bf16_f32 v27, v21, v17
    buffer_store_dwordx4 v[28:31], v252, s[24:27], s35 offen offset:0 sc1 nt
    v_cvt_pk_bf16_f32 v15, v22, v18
    buffer_store_dwordx4 v[24:27], v252, s[24:27], s35 offen offset:1024 sc1 nt
    v_cvt_pk_bf16_f32 v11, v23, v19
    buffer_store_dwordx4 v[12:15], v252, s[24:27], s35 offen offset:2048 sc1 nt
    v_max3_u32 v0, v4, v5, v6
    buffer_store_dwordx4 v[8:11], v252, s[24:27], s35 offen offset:3072 sc1 nt
    v_min3_u32 v1, v4, v5, v6
    v_max_u32 v0, v0, v7
    v_min_u32 v1, v1, v7
    v_cmp_le_u32_e64 s[54:55], s36, v0
    v_cmp_ge_u32_e64 s[56:57], s37, v1
L_fin:
    s_cbranch_vccnz L_exact_next
    s_or_b64 s[40:41], s[40:41], s[44:45]
    s_or_b64 s[40:41], s[40:41], s[54:55]
    s_or_b64 s[40:41], s[40:41], s[56:57]
    s_cbranch_scc1 L_exact
L_done:
L_end:
    s_endpgm
L_B:
    s_setprio 3
    v_and_b32 v215, 7, v208
    v_lshl_add_u32 v219, v211, 2, v213
    v_xor_b32 v219, v219, v215
    v_lshlrev_b32 v219, 4, v219
    v_and_b32 v220, 3, v210
    v_lshl_add_u32 v219, v220, 8, v219
    v_lshrrev_b32 v220, 2, v210
    v_lshl_add_u32 v247, v220, 10, v219
    v_lshl_add_u32 v246, v213, 12, v250
    s_mov_b32 s38, 0x3e0293ee
    s_mov_b32 s39, 0xffff0000
    s_mov_b32 s42, 0x05040100
    s_mov_b32 s43, 0x07060302
    s_waitcnt vmcnt(11)
    s_add_u32 m0, s29, 0x21000
    s_xor_b32 s31, s30, 0x11000
    buffer_load_dwordx4 v248, s[12:15], s31 offen offset:0  lds
    v_lshlrev_b32 v192, 16, v64
    v_and_b32 v193, s39, v64
    v_lshlrev_b32 v194, 16, v65
    v_and_b32 v195, s39, v65
    v_lshlrev_b32 v196, 16, v66
    v_and_b32 v197, s39, v66
    v_lshlrev_b32 v198, 16, v67
    v_and_b32 v199, s39, v67
    v_mul_f32 v192, s38, v192
    v_mul_f32 v193, s38, v193
    v_mul_f32 v194, s38, v194
    v_mul_f32 v195, s38, v195
    v_mul_f32 v196, s38, v196
    v_mul_f32 v197, s38, v197
    v_mul_f32 v198, s38, v198
    v_mul_f32 v199, s38, v199
    v_cvt_pk_bf16_f32 v64, v192, v193
    v_cvt_pk_bf16_f32 v65, v194, v195
    v_cvt_pk_bf16_f32 v66, v196, v197
    v_cvt_pk_bf16_f32 v67, v198, v199
    ds_write_b128 v247, v[64:67] offset:0
    s_waitcnt vmcnt(11)
    buffer_load_dwordx4 v249, s[12:15], s31 offen offset:1024  lds
    v_lshlrev_b32 v200, 16, v68
    v_and_b32 v201, s39, v68
    v_lshlrev_b32 v202, 16, v69
    v_and_b32 v203, s39, v69
    v_lshlrev_b32 v204, 16, v70
    v_and_b32 v205, s39, v70
    v_lshlrev_b32 v206, 16, v71
    v_and_b32 v207, s39, v71
    v_mul_f32 v200, s38, v200
    v_mul_f32 v201, s38, v201
    v_mul_f32 v202, s38, v202
    v_mul_f32 v203, s38, v203
    v_mul_f32 v204, s38, v204
    v_mul_f32 v205, s38, v205
    v_mul_f32 v206, s38, v206
    v_mul_f32 v207, s38, v207
    v_cvt_pk_bf16_f32 v68, v200, v201
    v_cvt_pk_bf16_f32 v69, v202, v203
    v_cvt_pk_bf16_f32 v70, v204, v205
    v_cvt_pk_bf16_f32 v71, v206, v207
    ds_write_b128 v247, v[68:71] offset:4096
    s_waitcnt vmcnt(11)
    buffer_load_dwordx4 v253, s[12:15], s31 offen offset:2048  lds
    v_lshlrev_b32 v192, 16, v72
    v_and_b32 v193, s39, v72
    v_lshlrev_b32 v194, 16, v73
    v_and_b32 v195, s39, v73
    v_lshlrev_b32 v196, 16, v74
    v_and_b32 v197, s39, v74
    v_lshlrev_b32 v198, 16, v75
    v_and_b32 v199, s39, v75
    v_mul_f32 v192, s38, v192
    v_mul_f32 v193, s38, v193
    v_mul_f32 v194, s38, v194
    v_mul_f32 v195, s38, v195
    v_mul_f32 v196, s38, v196
    v_mul_f32 v197, s38, v197
    v_mul_f32 v198, s38, v198
    v_mul_f32 v199, s38, v199
    v_cvt_pk_bf16_f32 v72, v192, v193
    v_cvt_pk_bf16_f32 v73, v194, v195
    v_cvt_pk_bf16_f32 v74, v196, v197
    v_cvt_pk_bf16_f32 v75, v198, v199
    ds_write_b128 v247, v[72:75] offset:8192
    s_waitcnt vmcnt(11)
    buffer_load_dwordx4 v254, s[12:15], s31 offen offset:3072  lds
    v_lshlrev_b32 v200, 16, v76
    v_and_b32 v201, s39, v76
    v_lshlrev_b32 v202, 16, v77
    v_and_b32 v203, s39, v77
    v_lshlrev_b32 v204, 16, v78
    v_and_b32 v205, s39, v78
    v_lshlrev_b32 v206, 16, v79
    v_and_b32 v207, s39, v79
    v_mul_f32 v200, s38, v200
    v_mul_f32 v201, s38, v201
    v_mul_f32 v202, s38, v202
    v_mul_f32 v203, s38, v203
    v_mul_f32 v204, s38, v204
    v_mul_f32 v205, s38, v205
    v_mul_f32 v206, s38, v206
    v_mul_f32 v207, s38, v207
    v_cvt_pk_bf16_f32 v76, v200, v201
    v_cvt_pk_bf16_f32 v77, v202, v203
    v_cvt_pk_bf16_f32 v78, v204, v205
    v_cvt_pk_bf16_f32 v79, v206, v207
    ds_write_b128 v247, v[76:79] offset:12288
    s_waitcnt vmcnt(11)
    buffer_load_dwordx4 v[0:3], v245, s[20:23], 0 offen offset:0
    v_lshlrev_b32 v192, 16, v80
    v_and_b32 v193, s39, v80
    v_lshlrev_b32 v194, 16, v81
    v_and_b32 v195, s39, v81
    v_lshlrev_b32 v196, 16, v82
    v_and_b32 v197, s39, v82
    v_lshlrev_b32 v198, 16, v83
    v_and_b32 v199, s39, v83
    v_mul_f32 v192, s38, v192
    v_mul_f32 v193, s38, v193
    v_mul_f32 v194, s38, v194
    v_mul_f32 v195, s38, v195
    v_mul_f32 v196, s38, v196
    v_mul_f32 v197, s38, v197
    v_mul_f32 v198, s38, v198
    v_mul_f32 v199, s38, v199
    v_cvt_pk_bf16_f32 v80, v192, v193
    v_cvt_pk_bf16_f32 v81, v194, v195
    v_cvt_pk_bf16_f32 v82, v196, v197
    v_cvt_pk_bf16_f32 v83, v198, v199
    ds_write_b128 v247, v[80:83] offset:16384
    s_waitcnt vmcnt(11)
    buffer_load_dwordx4 v[4:7], v245, s[20:23], 0 offen offset:1024
    v_lshlrev_b32 v200, 16, v84
    v_and_b32 v201, s39, v84
    v_lshlrev_b32 v202, 16, v85
    v_and_b32 v203, s39, v85
    v_lshlrev_b32 v204, 16, v86
    v_and_b32 v205, s39, v86
    v_lshlrev_b32 v206, 16, v87
    v_and_b32 v207, s39, v87
    v_mul_f32 v200, s38, v200
    v_mul_f32 v201, s38, v201
    v_mul_f32 v202, s38, v202
    v_mul_f32 v203, s38, v203
    v_mul_f32 v204, s38, v204
    v_mul_f32 v205, s38, v205
    v_mul_f32 v206, s38, v206
    v_mul_f32 v207, s38, v207
    v_cvt_pk_bf16_f32 v84, v200, v201
    v_cvt_pk_bf16_f32 v85, v202, v203
    v_cvt_pk_bf16_f32 v86, v204, v205
    v_cvt_pk_bf16_f32 v87, v206, v207
    ds_write_b128 v247, v[84:87] offset:20480
    s_waitcnt vmcnt(11)
    buffer_load_dwordx4 v[8:11], v245, s[20:23], 0 offen offset:2048
    v_lshlrev_b32 v192, 16, v88
    v_and_b32 v193, s39, v88
    v_lshlrev_b32 v194, 16, v89
    v_and_b32 v195, s39, v89
    v_lshlrev_b32 v196, 16, v90
    v_and_b32 v197, s39, v90
    v_lshlrev_b32 v198, 16, v91
    v_and_b32 v199, s39, v91
    v_mul_f32 v192, s38, v192
    v_mul_f32 v193, s38, v193
    v_mul_f32 v194, s38, v194
    v_mul_f32 v195, s38, v195
    v_mul_f32 v196, s38, v196
    v_mul_f32 v197, s38, v197
    v_mul_f32 v198, s38, v198
    v_mul_f32 v199, s38, v199
    v_cvt_pk_bf16_f32 v88, v192, v193
    v_cvt_pk_bf16_f32 v89, v194, v195
    v_cvt_pk_bf16_f32 v90, v196, v197
    v_cvt_pk_bf16_f32 v91, v198, v199
    ds_write_b128 v247, v[88:91] offset:24576
    s_waitcnt vmcnt(11)
    buffer_load_dwordx4 v[12:15], v245, s[20:23], 0 offen offset:3072
    v_lshlrev_b32 v200, 16, v92
    v_and_b32 v201, s39, v92
    v_lshlrev_b32 v202, 16, v93
    v_and_b32 v203, s39, v93
    v_lshlrev_b32 v204, 16, v94
    v_and_b32 v205, s39, v94
    v_lshlrev_b32 v206, 16, v95
    v_and_b32 v207, s39, v95
    v_mul_f32 v200, s38, v200
    v_mul_f32 v201, s38, v201
    v_mul_f32 v202, s38, v202
    v_mul_f32 v203, s38, v203
    v_mul_f32 v204, s38, v204
    v_mul_f32 v205, s38, v205
    v_mul_f32 v206, s38, v206
    v_mul_f32 v207, s38, v207
    v_cvt_pk_bf16_f32 v92, v200, v201
    v_cvt_pk_bf16_f32 v93, v202, v203
    v_cvt_pk_bf16_f32 v94, v204, v205
    v_cvt_pk_bf16_f32 v95, v206, v207
    ds_write_b128 v247, v[92:95] offset:28672
    s_waitcnt vmcnt(11)
    s_mov_b32 s47, 0x1000
    buffer_load_dwordx4 v[16:19], v245, s[20:23], s47 offen offset:0
    s_waitcnt vmcnt(11)
    buffer_load_dwordx4 v[20:23], v245, s[20:23], s47 offen offset:1024
    s_waitcnt vmcnt(11)
    buffer_load_dwordx4 v[24:27], v245, s[20:23], s47 offen offset:2048
    s_waitcnt vmcnt(11)
    buffer_load_dwordx4 v[28:31], v245, s[20:23], s47 offen offset:3072
    s_waitcnt vmcnt(11)
    s_mov_b32 s47, 0x8000
    buffer_load_dwordx4 v[96:99], v244, s[16:19], s47 offen offset:0
    s_waitcnt vmcnt(11)
    s_mov_b32 s47, 0x9000
    buffer_load_dwordx4 v[100:103], v244, s[16:19], s47 offen offset:0
    s_waitcnt vmcnt(11)
    s_mov_b32 s47, 0xa000
    buffer_load_dwordx4 v[104:107], v244, s[16:19], s47 offen offset:0
    s_waitcnt vmcnt(11)
    s_mov_b32 s47, 0xb000
    buffer_load_dwordx4 v[108:111], v244, s[16:19], s47 offen offset:0
    s_waitcnt lgkmcnt(0)
    s_barrier
    s_waitcnt vmcnt(11)
    s_mov_b32 s47, 0xc000
    buffer_load_dwordx4 v[112:115], v244, s[16:19], s47 offen offset:0
    s_waitcnt vmcnt(11)
    s_mov_b32 s47, 0xd000
    buffer_load_dwordx4 v[116:119], v244, s[16:19], s47 offen offset:0
    s_waitcnt vmcnt(11)
    s_mov_b32 s47, 0xe000
    buffer_load_dwordx4 v[120:123], v244, s[16:19], s47 offen offset:0
    s_waitcnt vmcnt(11)
    s_mov_b32 s47, 0xf000
    buffer_load_dwordx4 v[124:127], v244, s[16:19], s47 offen offset:0
    s_waitcnt vmcnt(11)
    s_mov_b32 s47, 0x8000
    buffer_load_dwordx4 v[32:35], v245, s[20:23], s47 offen offset:0
    s_waitcnt vmcnt(11)
    buffer_load_dwordx4 v[36:39], v245, s[20:23], s47 offen offset:1024
    s_waitcnt vmcnt(11)
    buffer_load_dwordx4 v[40:43], v245, s[20:23], s47 offen offset:2048
    s_waitcnt vmcnt(11)
    buffer_load_dwordx4 v[44:47], v245, s[20:23], s47 offen offset:3072
    v_perm_b32 v128, v4, v0, s42
    v_perm_b32 v129, v12, v8, s42
    v_perm_b32 v130, v20, v16, s42
    v_perm_b32 v131, v28, v24, s42
    ds_write_b128 v246, v[128:131] offset:0
    v_perm_b32 v132, v4, v0, s43
    v_perm_b32 v133, v12, v8, s43
    v_perm_b32 v134, v20, v16, s43
    v_perm_b32 v135, v28, v24, s43
    ds_write_b128 v246, v[132:135] offset:1024
    v_perm_b32 v136, v5, v1, s42
    v_perm_b32 v137, v13, v9, s42
    v_perm_b32 v138, v21, v17, s42
    v_perm_b32 v139, v29, v25, s42
    ds_write_b128 v246, v[136:139] offset:2048
    v_perm_b32 v140, v5, v1, s43
    v_perm_b32 v141, v13, v9, s43
    v_perm_b32 v142, v21, v17, s43
    v_perm_b32 v143, v29, v25, s43
    ds_write_b128 v246, v[140:143] offset:3072
    v_perm_b32 v144, v6, v2, s42
    v_perm_b32 v145, v14, v10, s42
    v_perm_b32 v146, v22, v18, s42
    v_perm_b32 v147, v30, v26, s42
    ds_write_b128 v246, v[144:147] offset:32768
    v_perm_b32 v148, v6, v2, s43
    v_perm_b32 v149, v14, v10, s43
    v_perm_b32 v150, v22, v18, s43
    v_perm_b32 v151, v30, v26, s43
    ds_write_b128 v246, v[148:151] offset:33792
    v_perm_b32 v152, v7, v3, s42
    v_perm_b32 v153, v15, v11, s42
    v_perm_b32 v154, v23, v19, s42
    v_perm_b32 v155, v31, v27, s42
    ds_write_b128 v246, v[152:155] offset:34816
    v_perm_b32 v156, v7, v3, s43
    v_perm_b32 v157, v15, v11, s43
    v_perm_b32 v158, v23, v19, s43
    v_perm_b32 v159, v31, v27, s43
    ds_write_b128 v246, v[156:159] offset:35840
    s_waitcnt lgkmcnt(0)
    s_barrier
    s_waitcnt vmcnt(11)
    s_mov_b32 s47, 0x9000
    buffer_load_dwordx4 v[48:51], v245, s[20:23], s47 offen offset:0
    v_lshlrev_b32 v192, 16, v96
    v_and_b32 v193, s39, v96
    v_lshlrev_b32 v194, 16, v97
    v_and_b32 v195, s39, v97
    v_lshlrev_b32 v196, 16, v98
    v_and_b32 v197, s39, v98
    v_lshlrev_b32 v198, 16, v99
    v_and_b32 v199, s39, v99
    v_mul_f32 v192, s38, v192
    v_mul_f32 v193, s38, v193
    v_mul_f32 v194, s38, v194
    v_mul_f32 v195, s38, v195
    v_mul_f32 v196, s38, v196
    v_mul_f32 v197, s38, v197
    v_mul_f32 v198, s38, v198
    v_mul_f32 v199, s38, v199
    v_cvt_pk_bf16_f32 v96, v192, v193
    v_cvt_pk_bf16_f32 v97, v194, v195
    v_cvt_pk_bf16_f32 v98, v196, v197
    v_cvt_pk_bf16_f32 v99, v198, v199
    ds_write_b128 v247, v[96:99] offset:32768
    s_waitcnt vmcnt(11)
    buffer_load_dwordx4 v[52:55], v245, s[20:23], s47 offen offset:1024
    v_lshlrev_b32 v200, 16, v100
    v_and_b32 v201, s39, v100
    v_lshlrev_b32 v202, 16, v101
    v_and_b32 v203, s39, v101
    v_lshlrev_b32 v204, 16, v102
    v_and_b32 v205, s39, v102
    v_lshlrev_b32 v206, 16, v103
    v_and_b32 v207, s39, v103
    v_mul_f32 v200, s38, v200
    v_mul_f32 v201, s38, v201
    v_mul_f32 v202, s38, v202
    v_mul_f32 v203, s38, v203
    v_mul_f32 v204, s38, v204
    v_mul_f32 v205, s38, v205
    v_mul_f32 v206, s38, v206
    v_mul_f32 v207, s38, v207
    v_cvt_pk_bf16_f32 v100, v200, v201
    v_cvt_pk_bf16_f32 v101, v202, v203
    v_cvt_pk_bf16_f32 v102, v204, v205
    v_cvt_pk_bf16_f32 v103, v206, v207
    ds_write_b128 v247, v[100:103] offset:36864
    s_waitcnt vmcnt(11)
    buffer_load_dwordx4 v[56:59], v245, s[20:23], s47 offen offset:2048
    v_lshlrev_b32 v192, 16, v104
    v_and_b32 v193, s39, v104
    v_lshlrev_b32 v194, 16, v105
    v_and_b32 v195, s39, v105
    v_lshlrev_b32 v196, 16, v106
    v_and_b32 v197, s39, v106
    v_lshlrev_b32 v198, 16, v107
    v_and_b32 v199, s39, v107
    v_mul_f32 v192, s38, v192
    v_mul_f32 v193, s38, v193
    v_mul_f32 v194, s38, v194
    v_mul_f32 v195, s38, v195
    v_mul_f32 v196, s38, v196
    v_mul_f32 v197, s38, v197
    v_mul_f32 v198, s38, v198
    v_mul_f32 v199, s38, v199
    v_cvt_pk_bf16_f32 v104, v192, v193
    v_cvt_pk_bf16_f32 v105, v194, v195
    v_cvt_pk_bf16_f32 v106, v196, v197
    v_cvt_pk_bf16_f32 v107, v198, v199
    ds_write_b128 v247, v[104:107] offset:40960
    s_waitcnt vmcnt(11)
    buffer_load_dwordx4 v[60:63], v245, s[20:23], s47 offen offset:3072
    v_lshlrev_b32 v200, 16, v108
    v_and_b32 v201, s39, v108
    v_lshlrev_b32 v202, 16, v109
    v_and_b32 v203, s39, v109
    v_lshlrev_b32 v204, 16, v110
    v_and_b32 v205, s39, v110
    v_lshlrev_b32 v206, 16, v111
    v_and_b32 v207, s39, v111
    v_mul_f32 v200, s38, v200
    v_mul_f32 v201, s38, v201
    v_mul_f32 v202, s38, v202
    v_mul_f32 v203, s38, v203
    v_mul_f32 v204, s38, v204
    v_mul_f32 v205, s38, v205
    v_mul_f32 v206, s38, v206
    v_mul_f32 v207, s38, v207
    v_cvt_pk_bf16_f32 v108, v200, v201
    v_cvt_pk_bf16_f32 v109, v202, v203
    v_cvt_pk_bf16_f32 v110, v204, v205
    v_cvt_pk_bf16_f32 v111, v206, v207
    ds_write_b128 v247, v[108:111] offset:45056
    s_waitcnt vmcnt(11)
    s_add_u32 m0, s29, 0x20000
    s_xor_b32 s31, s30, 0x0
    buffer_load_dwordx4 v248, s[12:15], s31 offen offset:0  lds
    v_lshlrev_b32 v192, 16, v112
    v_and_b32 v193, s39, v112
    v_lshlrev_b32 v194, 16, v113
    v_and_b32 v195, s39, v113
    v_lshlrev_b32 v196, 16, v114
    v_and_b32 v197, s39, v114
    v_lshlrev_b32 v198, 16, v115
    v_and_b32 v199, s39, v115
    v_mul_f32 v192, s38, v192
    v_mul_f32 v193, s38, v193
    v_mul_f32 v194, s38, v194
    v_mul_f32 v195, s38, v195
    v_mul_f32 v196, s38, v196
    v_mul_f32 v197, s38, v197
    v_mul_f32 v198, s38, v198
    v_mul_f32 v199, s38, v199
    v_cvt_pk_bf16_f32 v112, v192, v193
    v_cvt_pk_bf16_f32 v113, v194, v195
    v_cvt_pk_bf16_f32 v114, v196, v197
    v_cvt_pk_bf16_f32 v115, v198, v199
    ds_write_b128 v247, v[112:115] offset:49152
    s_waitcnt vmcnt(11)
    buffer_load_dwordx4 v249, s[12:15], s31 offen offset:1024  lds
    v_lshlrev_b32 v200, 16, v116
    v_and_b32 v201, s39, v116
    v_lshlrev_b32 v202, 16, v117
    v_and_b32 v203, s39, v117
    v_lshlrev_b32 v204, 16, v118
    v_and_b32 v205, s39, v118
    v_lshlrev_b32 v206, 16, v119
    v_and_b32 v207, s39, v119
    v_mul_f32 v200, s38, v200
    v_mul_f32 v201, s38, v201
    v_mul_f32 v202, s38, v202
    v_mul_f32 v203, s38, v203
    v_mul_f32 v204, s38, v204
    v_mul_f32 v205, s38, v205
    v_mul_f32 v206, s38, v206
    v_mul_f32 v207, s38, v207
    v_cvt_pk_bf16_f32 v116, v200, v201
    v_cvt_pk_bf16_f32 v117, v202, v203
    v_cvt_pk_bf16_f32 v118, v204, v205
    v_cvt_pk_bf16_f32 v119, v206, v207
    ds_write_b128 v247, v[116:119] offset:53248
    s_waitcnt vmcnt(11)
    buffer_load_dwordx4 v253, s[12:15], s31 offen offset:2048  lds
    v_lshlrev_b32 v192, 16, v120
    v_and_b32 v193, s39, v120
    v_lshlrev_b32 v194, 16, v121
    v_and_b32 v195, s39, v121
    v_lshlrev_b32 v196, 16, v122
    v_and_b32 v197, s39, v122
    v_lshlrev_b32 v198, 16, v123
    v_and_b32 v199, s39, v123
    v_mul_f32 v192, s38, v192
    v_mul_f32 v193, s38, v193
    v_mul_f32 v194, s38, v194
    v_mul_f32 v195, s38, v195
    v_mul_f32 v196, s38, v196
    v_mul_f32 v197, s38, v197
    v_mul_f32 v198, s38, v198
    v_mul_f32 v199, s38, v199
    v_cvt_pk_bf16_f32 v120, v192, v193
    v_cvt_pk_bf16_f32 v121, v194, v195
    v_cvt_pk_bf16_f32 v122, v196, v197
    v_cvt_pk_bf16_f32 v123, v198, v199
    ds_write_b128 v247, v[120:123] offset:57344
    s_waitcnt vmcnt(11)
    buffer_load_dwordx4 v254, s[12:15], s31 offen offset:3072  lds
    v_lshlrev_b32 v200, 16, v124
    v_and_b32 v201, s39, v124
    v_lshlrev_b32 v202, 16, v125
    v_and_b32 v203, s39, v125
    v_lshlrev_b32 v204, 16, v126
    v_and_b32 v205, s39, v126
    v_lshlrev_b32 v206, 16, v127
    v_and_b32 v207, s39, v127
    v_mul_f32 v200, s38, v200
    v_mul_f32 v201, s38, v201
    v_mul_f32 v202, s38, v202
    v_mul_f32 v203, s38, v203
    v_mul_f32 v204, s38, v204
    v_mul_f32 v205, s38, v205
    v_mul_f32 v206, s38, v206
    v_mul_f32 v207, s38, v207
    v_cvt_pk_bf16_f32 v124, v200, v201
    v_cvt_pk_bf16_f32 v125, v202, v203
    v_cvt_pk_bf16_f32 v126, v204, v205
    v_cvt_pk_bf16_f32 v127, v206, v207
    ds_write_b128 v247, v[124:127] offset:61440
    s_waitcnt lgkmcnt(0)
    s_barrier
    s_waitcnt vmcnt(11)
    s_add_u32 m0, s29, 0x21000
    s_xor_b32 s31, s30, 0x1000
    buffer_load_dwordx4 v248, s[12:15], s31 offen offset:0  lds
    s_waitcnt vmcnt(11)
    buffer_load_dwordx4 v249, s[12:15], s31 offen offset:1024  lds
    s_waitcnt vmcnt(11)
    buffer_load_dwordx4 v253, s[12:15], s31 offen offset:2048  lds
    s_waitcnt vmcnt(11)
    buffer_load_dwordx4 v254, s[12:15], s31 offen offset:3072  lds
    s_waitcnt vmcnt(8)
    v_perm_b32 v160, v36, v32, s42
    v_perm_b32 v161, v44, v40, s42
    v_perm_b32 v162, v52, v48, s42
    v_perm_b32 v163, v60, v56, s42
    ds_write_b128 v246, v[160:163] offset:16384
    v_perm_b32 v164, v36, v32, s43
    v_perm_b32 v165, v44, v40, s43
    v_perm_b32 v166, v52, v48, s43
    v_perm_b32 v167, v60, v56, s43
    ds_write_b128 v246, v[164:167] offset:17408
    v_perm_b32 v168, v37, v33, s42
    v_perm_b32 v169, v45, v41, s42
    v_perm_b32 v170, v53, v49, s42
    v_perm_b32 v171, v61, v57, s42
    ds_write_b128 v246, v[168:171] offset:18432
    v_perm_b32 v172, v37, v33, s43
    v_perm_b32 v173, v45, v41, s43
    v_perm_b32 v174, v53, v49, s43
    v_perm_b32 v175, v61, v57, s43
    ds_write_b128 v246, v[172:175] offset:19456
    v_perm_b32 v176, v38, v34, s42
    v_perm_b32 v177, v46, v42, s42
    v_perm_b32 v178, v54, v50, s42
    v_perm_b32 v179, v62, v58, s42
    ds_write_b128 v246, v[176:179] offset:49152
    v_perm_b32 v180, v38, v34, s43
    v_perm_b32 v181, v46, v42, s43
    v_perm_b32 v182, v54, v50, s43
    v_perm_b32 v183, v62, v58, s43
    ds_write_b128 v246, v[180:183] offset:50176
    v_perm_b32 v184, v39, v35, s42
    v_perm_b32 v185, v47, v43, s42
    v_perm_b32 v186, v55, v51, s42
    v_perm_b32 v187, v63, v59, s42
    ds_write_b128 v246, v[184:187] offset:51200
    v_perm_b32 v188, v39, v35, s43
    v_perm_b32 v189, v47, v43, s43
    v_perm_b32 v190, v55, v51, s43
    v_perm_b32 v191, v63, v59, s43
    ds_write_b128 v246, v[188:191] offset:52224
    s_waitcnt lgkmcnt(0)
    s_barrier
    ds_read_b128 v[196:199], v248 offset:0
    ds_read_b128 v[200:203], v249 offset:1024
    ds_read_b128 v[204:207], v248 offset:2048
    ds_read_b128 v[208:211], v249 offset:3072
    ds_read_b128 v[212:215], v248 offset:4096
    ds_read_b128 v[216:219], v249 offset:5120
    ds_read_b128 v[220:223], v248 offset:6144
    v_xor_b32 v244, 0x40, v251
    v_xor_b32 v245, 0x80, v251
    v_xor_b32 v246, 0xc0, v251
    v_bfe_u32 v253, v252, 6, 4
    v_and_b32 v254, 0x1c030, v252
    v_lshl_add_u32 v254, v253, 8, v254
    v_bfe_u32 v255, v252, 8, 2
    v_bfe_u32 v253, v252, 6, 2
    v_lshl_add_u32 v255, v253, 2, v255
    v_and_b32 v253, 0x30, v252
    v_add_lshl_u32 v255, v253, v255, 2
    s_waitcnt vmcnt(0)
    ds_read_b128 v[128:131], v251 offset:0
    ds_read_b128 v[124:127], v251 offset:4096
    ds_read_b128 v[116:119], v244 offset:0
    ds_read_b128 v[112:115], v244 offset:4096
    ds_read_b128 v[108:111], v245 offset:0
    ds_read_b128 v[104:107], v245 offset:4096
    ds_read_b128 v[100:103], v246 offset:0
    ds_read_b128 v[96:99], v246 offset:4096
    v_mbcnt_lo_u32_b32 v253, -1, 0
    v_mbcnt_hi_u32_b32 v253, -1, v253
    v_lshlrev_b32 v253, 7, v253
    s_xor_b32 s47, s30, 0x12000
    buffer_load_dword v251, v253, s[12:15], s47 offen
    s_xor_b32 s47, s30, 0x2000
    buffer_load_dword v253, v253, s[12:15], s47 offen
L_body:
    s_setprio 2
    s_waitcnt lgkmcnt(13)
    s_waitcnt lgkmcnt(7)
    v_mfma_f32_16x16x32_bf16 v[120:123], v[196:199], v[128:131], 0
    ds_read_b128 v[224:227], v249 offset:7168
    ds_read_b128 v[228:231], v248 offset:8192
    s_waitcnt lgkmcnt(8)
    v_mfma_f32_16x16x32_bf16 v[92:95], v[196:199], v[124:127], 0
    ds_read_b128 v[232:235], v249 offset:9216
    s_waitcnt lgkmcnt(8)
    v_mfma_f32_16x16x32_bf16 v[120:123], v[200:203], v[116:119], v[120:123]
    s_waitcnt lgkmcnt(7)
    v_mfma_f32_16x16x32_bf16 v[92:95], v[200:203], v[112:115], v[92:95]
    ds_read_b128 v[196:199], v248 offset:10240
    s_waitcnt lgkmcnt(7)
    v_mfma_f32_16x16x32_bf16 v[120:123], v[204:207], v[108:111], v[120:123]
    s_waitcnt lgkmcnt(6)
    v_mfma_f32_16x16x32_bf16 v[92:95], v[204:207], v[104:107], v[92:95]
    ds_read_b128 v[200:203], v249 offset:11264
    s_waitcnt lgkmcnt(6)
    v_mfma_f32_16x16x32_bf16 v[120:123], v[208:211], v[100:103], v[120:123]
    s_waitcnt lgkmcnt(5)
    v_mfma_f32_16x16x32_bf16 v[92:95], v[208:211], v[96:99], v[92:95]
    ds_read_b128 v[204:207], v248 offset:12288
    v_mfma_f32_16x16x32_bf16 v[4:7], v[212:215], v[128:131], 0
    v_mfma_f32_16x16x32_bf16 v[0:3], v[212:215], v[124:127], 0
    ds_read_b128 v[208:211], v249 offset:13312
    v_mfma_f32_16x16x32_bf16 v[4:7], v[216:219], v[116:119], v[4:7]
    v_mfma_f32_16x16x32_bf16 v[0:3], v[216:219], v[112:115], v[0:3]
    ds_read_b128 v[212:215], v248 offset:14336
    v_max3_f32 v8, v120, v121, v122
    v_max3_f32 v8, v8, v123, v92
    v_mfma_f32_16x16x32_bf16 v[4:7], v[220:223], v[108:111], v[4:7]
    v_max3_f32 v8, v8, v93, v94
    v_max_f32 v8, v8, v95
    v_mfma_f32_16x16x32_bf16 v[0:3], v[220:223], v[104:107], v[0:3]
    ds_read_b128 v[216:219], v249 offset:15360
    v_mov_b32 v9, v8
    s_waitcnt lgkmcnt(8)
    v_mfma_f32_16x16x32_bf16 v[4:7], v[224:227], v[100:103], v[4:7]
    v_mfma_f32_16x16x32_bf16 v[0:3], v[224:227], v[96:99], v[0:3]
    ds_read_b128 v[220:223], v250 offset:0
    v_permlane32_swap_b32 v8, v9
    s_waitcnt lgkmcnt(7)
    v_mfma_f32_16x16x32_bf16 v[88:91], v[228:231], v[128:131], 0
    v_max_f32 v8, v8, v9
    v_mov_b32 v9, v8
    v_mfma_f32_16x16x32_bf16 v[76:79], v[228:231], v[124:127], 0
    ds_read_b128 v[224:227], v250 offset:1024
    v_mfma_f32_16x16x32_bf16 v[88:91], v[232:235], v[116:119], v[88:91]
    v_permlane16_swap_b32 v8, v9
    v_mfma_f32_16x16x32_bf16 v[76:79], v[232:235], v[112:115], v[76:79]
    ds_read_b128 v[228:231], v250 offset:2048
    s_cbranch_vccnz L_s1
    v_min_f32_e64 v244, -v8, -v9
    v_min_f32_e64 v245, -v8, -v9
    v_min_f32_e64 v246, -v8, -v9
    v_min_f32_e64 v247, -v8, -v9
L_s1:
    s_waitcnt lgkmcnt(7)
    v_mfma_f32_16x16x32_bf16 v[88:91], v[196:199], v[108:111], v[88:91]
    v_add_f32 v120, v120, v244
    v_add_f32 v121, v121, v244
    v_add_f32 v122, v122, v244
    v_add_f32 v123, v123, v244
    v_exp_f32 v120, v120
    v_exp_f32 v121, v121
    v_exp_f32 v122, v122
    v_exp_f32 v123, v123
    v_add_f32 v92, v92, v244
    v_add_f32 v93, v93, v244
    v_add_f32 v94, v94, v244
    v_add_f32 v95, v95, v244
    v_exp_f32 v92, v92
    v_exp_f32 v93, v93
    v_exp_f32 v94, v94
    v_mfma_f32_16x16x32_bf16 v[76:79], v[196:199], v[104:107], v[76:79]
    ds_read_b128 v[232:235], v250 offset:3072
    v_exp_f32 v95, v95
    v_add_f32 v4, v4, v244
    v_cvt_pk_bf16_f32 v120, v120, v121
    v_mfma_f32_16x16x32_bf16 v[88:91], v[200:203], v[100:103], v[88:91]
    v_add_f32 v5, v5, v244
    v_add_f32 v6, v6, v244
    v_add_f32 v7, v7, v244
    v_mfma_f32_16x16x32_bf16 v[76:79], v[200:203], v[96:99], v[76:79]
    ds_read_b128 v[196:199], v250 offset:32768
    v_exp_f32 v4, v4
    v_exp_f32 v5, v5
    v_cvt_pk_bf16_f32 v121, v122, v123
    s_waitcnt lgkmcnt(7)
    v_mfma_f32_16x16x32_bf16 v[72:75], v[204:207], v[128:131], v[244:247]
    v_exp_f32 v6, v6
    v_mfma_f32_16x16x32_bf16 v[68:71], v[204:207], v[124:127], v[244:247]
    ds_read_b128 v[200:203], v250 offset:33792
    v_exp_f32 v7, v7
    v_cvt_pk_bf16_f32 v92, v92, v93
    v_mfma_f32_16x16x32_bf16 v[72:75], v[208:211], v[116:119], v[72:75]
    v_add_f32 v0, v0, v244
    v_add_f32 v1, v1, v244
    v_mfma_f32_16x16x32_bf16 v[68:71], v[208:211], v[112:115], v[68:71]
    ds_read_b128 v[204:207], v250 offset:34816
    v_add_f32 v2, v2, v244
    v_add_f32 v3, v3, v244
    v_exp_f32 v0, v0
    s_waitcnt lgkmcnt(7)
    v_mfma_f32_16x16x32_bf16 v[72:75], v[212:215], v[108:111], v[72:75]
    v_exp_f32 v1, v1
    v_cvt_pk_bf16_f32 v93, v94, v95
    v_cvt_pk_bf16_f32 v122, v4, v5
    v_mfma_f32_16x16x32_bf16 v[68:71], v[212:215], v[104:107], v[68:71]
    ds_read_b128 v[208:211], v250 offset:35840
    v_exp_f32 v2, v2
    v_cvt_pk_bf16_f32 v123, v6, v7
    v_mfma_f32_16x16x32_bf16 v[72:75], v[216:219], v[100:103], v[72:75]
    v_exp_f32 v3, v3
    v_cvt_pk_bf16_f32 v94, v0, v1
    v_mfma_f32_16x16x32_bf16 v[68:71], v[216:219], v[96:99], v[68:71]
    ds_read_b128 v[212:215], v248 offset:16384
    v_cvt_pk_bf16_f32 v95, v2, v3
    s_waitcnt lgkmcnt(7)
    v_mfma_f32_16x16x32_bf16 v[28:31], v[120:123], v[220:223], 0
    v_add_f32 v88, v88, v244
    v_add_f32 v89, v89, v244
    v_mfma_f32_16x16x32_bf16 v[12:15], v[92:95], v[220:223], 0
    ds_read_b128 v[216:219], v249 offset:17408
    v_add_f32 v90, v90, v244
    v_mfma_f32_16x16x32_bf16 v[24:27], v[120:123], v[224:227], 0
    v_add_f32 v91, v91, v244
    v_mfma_f32_16x16x32_bf16 v[8:11], v[92:95], v[224:227], 0
    ds_read_b128 v[220:223], v248 offset:18432
    v_mfma_f32_16x16x32_bf16 v[36:39], v[120:123], v[236:239], 0
    s_waitcnt lgkmcnt(7)
    v_mfma_f32_16x16x32_bf16 v[20:23], v[120:123], v[228:231], 0
    ds_read_b128 v[224:227], v249 offset:19456
    v_mfma_f32_16x16x32_bf16 v[4:7], v[92:95], v[228:231], 0
    v_exp_f32 v88, v88
    v_mfma_f32_16x16x32_bf16 v[16:19], v[120:123], v[232:235], 0
    v_exp_f32 v89, v89
    v_mfma_f32_16x16x32_bf16 v[0:3], v[92:95], v[232:235], 0
    ds_read_b128 v[228:231], v248 offset:20480
    s_waitcnt lgkmcnt(7)
    v_mfma_f32_16x16x32_bf16 v[64:67], v[120:123], v[196:199], 0
    v_exp_f32 v90, v90
    v_mfma_f32_16x16x32_bf16 v[48:51], v[92:95], v[196:199], 0
    ds_read_b128 v[232:235], v249 offset:21504
    v_cvt_pk_bf16_f32 v88, v88, v89
    v_mfma_f32_16x16x32_bf16 v[36:39], v[92:95], v[240:243], v[36:39]
    v_exp_f32 v91, v91
    v_mfma_f32_16x16x32_bf16 v[60:63], v[120:123], v[200:203], 0
    ds_read_b128 v[196:199], v248 offset:22528
    v_add_f32 v76, v76, v244
    v_mfma_f32_16x16x32_bf16 v[32:35], v[92:95], v[200:203], 0
    v_add_f32 v77, v77, v244
    s_waitcnt lgkmcnt(7)
    v_mfma_f32_16x16x32_bf16 v[56:59], v[120:123], v[204:207], 0
    v_add_f32 v78, v78, v244
    v_add_f32 v79, v79, v244
    v_mfma_f32_16x16x32_bf16 v[44:47], v[92:95], v[204:207], 0
    ds_read_b128 v[200:203], v249 offset:23552
    v_cvt_pk_bf16_f32 v89, v90, v91
    v_mfma_f32_16x16x32_bf16 v[52:55], v[120:123], v[208:211], 0
    v_exp_f32 v76, v76
    v_mfma_f32_16x16x32_bf16 v[40:43], v[92:95], v[208:211], 0
    ds_read_b128 v[204:207], v250 offset:4096
    s_waitcnt lgkmcnt(7)
    v_mfma_f32_16x16x32_bf16 v[84:87], v[212:215], v[128:131], v[244:247]
    v_exp_f32 v77, v77
    v_mfma_f32_16x16x32_bf16 v[80:83], v[212:215], v[124:127], v[244:247]
    ds_read_b128 v[208:211], v250 offset:5120
    v_cvt_pk_bf16_f32 v76, v76, v77
    v_mfma_f32_16x16x32_bf16 v[84:87], v[216:219], v[116:119], v[84:87]
    v_exp_f32 v78, v78
    v_mfma_f32_16x16x32_bf16 v[80:83], v[216:219], v[112:115], v[80:83]
    ds_read_b128 v[212:215], v250 offset:6144
    s_waitcnt lgkmcnt(7)
    v_mfma_f32_16x16x32_bf16 v[84:87], v[220:223], v[108:111], v[84:87]
    v_exp_f32 v79, v79
    v_mfma_f32_16x16x32_bf16 v[80:83], v[220:223], v[104:107], v[80:83]
    ds_read_b128 v[216:219], v250 offset:7168
    v_cvt_pk_bf16_f32 v77, v78, v79
    v_mfma_f32_16x16x32_bf16 v[84:87], v[224:227], v[100:103], v[84:87]
    v_exp_f32 v72, v72
    v_mfma_f32_16x16x32_bf16 v[80:83], v[224:227], v[96:99], v[80:83]
    ds_read_b128 v[220:223], v250 offset:36864
    s_waitcnt lgkmcnt(7)
    v_mfma_f32_16x16x32_bf16 v[120:123], v[228:231], v[128:131], v[244:247]
    v_exp_f32 v73, v73
    v_mfma_f32_16x16x32_bf16 v[92:95], v[228:231], v[124:127], v[244:247]
    ds_read_b128 v[224:227], v250 offset:37888
    v_cvt_pk_bf16_f32 v90, v72, v73
    v_mfma_f32_16x16x32_bf16 v[120:123], v[232:235], v[116:119], v[120:123]
    v_exp_f32 v74, v74
    v_exp_f32 v75, v75
    v_mfma_f32_16x16x32_bf16 v[92:95], v[232:235], v[112:115], v[92:95]
    ds_read_b128 v[228:231], v250 offset:38912
    v_exp_f32 v68, v68
    s_waitcnt lgkmcnt(7)
    v_mfma_f32_16x16x32_bf16 v[120:123], v[196:199], v[108:111], v[120:123]
    v_exp_f32 v69, v69
    v_mfma_f32_16x16x32_bf16 v[92:95], v[196:199], v[104:107], v[92:95]
    ds_read_b128 v[232:235], v250 offset:39936
    v_exp_f32 v70, v70
    v_cvt_pk_bf16_f32 v91, v74, v75
    v_mfma_f32_16x16x32_bf16 v[120:123], v[200:203], v[100:103], v[120:123]
    v_exp_f32 v71, v71
    v_cvt_pk_bf16_f32 v78, v68, v69
    v_mfma_f32_16x16x32_bf16 v[92:95], v[200:203], v[96:99], v[92:95]
    ds_read_b128 v[196:199], v248 offset:24576
    v_cvt_pk_bf16_f32 v79, v70, v71
    s_waitcnt lgkmcnt(7)
    v_mfma_f32_16x16x32_bf16 v[28:31], v[88:91], v[204:207], v[28:31]
    v_exp_f32 v84, v84
    v_mfma_f32_16x16x32_bf16 v[12:15], v[76:79], v[204:207], v[12:15]
    ds_read_b128 v[200:203], v249 offset:25600
    v_mfma_f32_16x16x32_bf16 v[24:27], v[88:91], v[208:211], v[24:27]
    v_exp_f32 v85, v85
    v_mfma_f32_16x16x32_bf16 v[8:11], v[76:79], v[208:211], v[8:11]
    ds_read_b128 v[204:207], v248 offset:26624
    v_cvt_pk_bf16_f32 v84, v84, v85
    v_mfma_f32_16x16x32_bf16 v[36:39], v[88:91], v[236:239], v[36:39]
    s_waitcnt lgkmcnt(7)
    v_mfma_f32_16x16x32_bf16 v[20:23], v[88:91], v[212:215], v[20:23]
    ds_read_b128 v[208:211], v249 offset:27648
    v_mfma_f32_16x16x32_bf16 v[4:7], v[76:79], v[212:215], v[4:7]
    v_exp_f32 v86, v86
    v_mfma_f32_16x16x32_bf16 v[16:19], v[88:91], v[216:219], v[16:19]
    v_exp_f32 v87, v87
    v_mfma_f32_16x16x32_bf16 v[0:3], v[76:79], v[216:219], v[0:3]
    ds_read_b128 v[212:215], v248 offset:28672
    s_waitcnt lgkmcnt(7)
    v_mfma_f32_16x16x32_bf16 v[64:67], v[88:91], v[220:223], v[64:67]
    v_exp_f32 v80, v80
    v_mfma_f32_16x16x32_bf16 v[48:51], v[76:79], v[220:223], v[48:51]
    ds_read_b128 v[216:219], v249 offset:29696
    v_cvt_pk_bf16_f32 v85, v86, v87
    v_mfma_f32_16x16x32_bf16 v[36:39], v[76:79], v[240:243], v[36:39]
    v_exp_f32 v81, v81
    v_mfma_f32_16x16x32_bf16 v[60:63], v[88:91], v[224:227], v[60:63]
    ds_read_b128 v[220:223], v248 offset:30720
    v_cvt_pk_bf16_f32 v80, v80, v81
    v_mfma_f32_16x16x32_bf16 v[32:35], v[76:79], v[224:227], v[32:35]
    s_waitcnt lgkmcnt(7)
    v_mfma_f32_16x16x32_bf16 v[56:59], v[88:91], v[228:231], v[56:59]
    v_exp_f32 v82, v82
    v_mfma_f32_16x16x32_bf16 v[44:47], v[76:79], v[228:231], v[44:47]
    ds_read_b128 v[224:227], v249 offset:31744
    v_mfma_f32_16x16x32_bf16 v[52:55], v[88:91], v[232:235], v[52:55]
    v_exp_f32 v83, v83
    v_mfma_f32_16x16x32_bf16 v[40:43], v[76:79], v[232:235], v[40:43]
    ds_read_b128 v[228:231], v250 offset:8192
    s_waitcnt lgkmcnt(7)
    v_mfma_f32_16x16x32_bf16 v[72:75], v[196:199], v[128:131], v[244:247]
    v_exp_f32 v120, v120
    v_mfma_f32_16x16x32_bf16 v[68:71], v[196:199], v[124:127], v[244:247]
    ds_read_b128 v[232:235], v250 offset:9216
    v_cvt_pk_bf16_f32 v81, v82, v83
    v_mfma_f32_16x16x32_bf16 v[72:75], v[200:203], v[116:119], v[72:75]
    v_exp_f32 v121, v121
    v_mfma_f32_16x16x32_bf16 v[68:71], v[200:203], v[112:115], v[68:71]
    ds_read_b128 v[196:199], v250 offset:10240
    s_waitcnt lgkmcnt(7)
    v_mfma_f32_16x16x32_bf16 v[72:75], v[204:207], v[108:111], v[72:75]
    v_exp_f32 v122, v122
    v_mfma_f32_16x16x32_bf16 v[68:71], v[204:207], v[104:107], v[68:71]
    ds_read_b128 v[200:203], v250 offset:11264
    v_cvt_pk_bf16_f32 v86, v120, v121
    v_mfma_f32_16x16x32_bf16 v[72:75], v[208:211], v[100:103], v[72:75]
    v_exp_f32 v123, v123
    v_mfma_f32_16x16x32_bf16 v[68:71], v[208:211], v[96:99], v[68:71]
    ds_read_b128 v[204:207], v250 offset:40960
    s_waitcnt lgkmcnt(7)
    v_mfma_f32_16x16x32_bf16 v[88:91], v[212:215], v[128:131], v[244:247]
    v_exp_f32 v92, v92
    v_mfma_f32_16x16x32_bf16 v[76:79], v[212:215], v[124:127], v[244:247]
    ds_read_b128 v[208:211], v250 offset:41984
    v_cvt_pk_bf16_f32 v87, v122, v123
    v_mfma_f32_16x16x32_bf16 v[88:91], v[216:219], v[116:119], v[88:91]
    v_exp_f32 v93, v93
    v_mfma_f32_16x16x32_bf16 v[76:79], v[216:219], v[112:115], v[76:79]
    ds_read_b128 v[212:215], v250 offset:43008
    s_waitcnt lgkmcnt(7)
    v_mfma_f32_16x16x32_bf16 v[88:91], v[220:223], v[108:111], v[88:91]
    v_exp_f32 v94, v94
    v_mfma_f32_16x16x32_bf16 v[76:79], v[220:223], v[104:107], v[76:79]
    ds_read_b128 v[216:219], v250 offset:44032
    v_cvt_pk_bf16_f32 v82, v92, v93
    v_mfma_f32_16x16x32_bf16 v[88:91], v[224:227], v[100:103], v[88:91]
    v_exp_f32 v95, v95
    v_mfma_f32_16x16x32_bf16 v[76:79], v[224:227], v[96:99], v[76:79]
    ds_read_b128 v[220:223], v248 offset:32768
    v_cvt_pk_bf16_f32 v83, v94, v95
    s_waitcnt lgkmcnt(7)
    v_mfma_f32_16x16x32_bf16 v[28:31], v[84:87], v[228:231], v[28:31]
    v_exp_f32 v72, v72
    v_mfma_f32_16x16x32_bf16 v[12:15], v[80:83], v[228:231], v[12:15]
    ds_read_b128 v[224:227], v249 offset:33792
    v_mfma_f32_16x16x32_bf16 v[24:27], v[84:87], v[232:235], v[24:27]
    v_exp_f32 v73, v73
    v_mfma_f32_16x16x32_bf16 v[8:11], v[80:83], v[232:235], v[8:11]
    ds_read_b128 v[228:231], v248 offset:34816
    v_cvt_pk_bf16_f32 v72, v72, v73
    v_mfma_f32_16x16x32_bf16 v[36:39], v[84:87], v[236:239], v[36:39]
    s_waitcnt lgkmcnt(7)
    v_mfma_f32_16x16x32_bf16 v[20:23], v[84:87], v[196:199], v[20:23]
    ds_read_b128 v[232:235], v249 offset:35840
    v_mfma_f32_16x16x32_bf16 v[4:7], v[80:83], v[196:199], v[4:7]
    v_exp_f32 v74, v74
    v_mfma_f32_16x16x32_bf16 v[16:19], v[84:87], v[200:203], v[16:19]
    v_exp_f32 v75, v75
    v_mfma_f32_16x16x32_bf16 v[0:3], v[80:83], v[200:203], v[0:3]
    ds_read_b128 v[196:199], v248 offset:36864
    s_waitcnt lgkmcnt(7)
    v_mfma_f32_16x16x32_bf16 v[64:67], v[84:87], v[204:207], v[64:67]
    v_exp_f32 v68, v68
    v_mfma_f32_16x16x32_bf16 v[48:51], v[80:83], v[204:207], v[48:51]
    ds_read_b128 v[200:203], v249 offset:37888
    v_cvt_pk_bf16_f32 v73, v74, v75
    v_mfma_f32_16x16x32_bf16 v[36:39], v[80:83], v[240:243], v[36:39]
    v_exp_f32 v69, v69
    v_mfma_f32_16x16x32_bf16 v[60:63], v[84:87], v[208:211], v[60:63]
    ds_read_b128 v[204:207], v248 offset:38912
    v_cvt_pk_bf16_f32 v68, v68, v69
    v_mfma_f32_16x16x32_bf16 v[32:35], v[80:83], v[208:211], v[32:35]
    s_waitcnt lgkmcnt(7)
    v_mfma_f32_16x16x32_bf16 v[56:59], v[84:87], v[212:215], v[56:59]
    v_exp_f32 v70, v70
    v_mfma_f32_16x16x32_bf16 v[44:47], v[80:83], v[212:215], v[44:47]
    ds_read_b128 v[208:211], v249 offset:39936
    v_mfma_f32_16x16x32_bf16 v[52:55], v[84:87], v[216:219], v[52:55]
    v_exp_f32 v71, v71
    v_mfma_f32_16x16x32_bf16 v[40:43], v[80:83], v[216:219], v[40:43]
    ds_read_b128 v[212:215], v250 offset:12288
    s_waitcnt lgkmcnt(7)
    v_mfma_f32_16x16x32_bf16 v[120:123], v[220:223], v[128:131], v[244:247]
    v_exp_f32 v88, v88
    v_mfma_f32_16x16x32_bf16 v[92:95], v[220:223], v[124:127], v[244:247]
    ds_read_b128 v[216:219], v250 offset:13312
    v_cvt_pk_bf16_f32 v69, v70, v71
    v_mfma_f32_16x16x32_bf16 v[120:123], v[224:227], v[116:119], v[120:123]
    v_exp_f32 v89, v89
    v_mfma_f32_16x16x32_bf16 v[92:95], v[224:227], v[112:115], v[92:95]
    ds_read_b128 v[220:223], v250 offset:14336
    s_waitcnt lgkmcnt(7)
    v_mfma_f32_16x16x32_bf16 v[120:123], v[228:231], v[108:111], v[120:123]
    v_exp_f32 v90, v90
    v_mfma_f32_16x16x32_bf16 v[92:95], v[228:231], v[104:107], v[92:95]
    ds_read_b128 v[224:227], v250 offset:15360
    v_cvt_pk_bf16_f32 v74, v88, v89
    v_mfma_f32_16x16x32_bf16 v[120:123], v[232:235], v[100:103], v[120:123]
    v_exp_f32 v91, v91
    v_mfma_f32_16x16x32_bf16 v[92:95], v[232:235], v[96:99], v[92:95]
    ds_read_b128 v[228:231], v250 offset:45056
    s_waitcnt lgkmcnt(7)
    v_mfma_f32_16x16x32_bf16 v[84:87], v[196:199], v[128:131], v[244:247]
    v_exp_f32 v76, v76
    v_mfma_f32_16x16x32_bf16 v[80:83], v[196:199], v[124:127], v[244:247]
    ds_read_b128 v[232:235], v250 offset:46080
    v_cvt_pk_bf16_f32 v75, v90, v91
    v_mfma_f32_16x16x32_bf16 v[84:87], v[200:203], v[116:119], v[84:87]
    v_exp_f32 v77, v77
    v_mfma_f32_16x16x32_bf16 v[80:83], v[200:203], v[112:115], v[80:83]
    ds_read_b128 v[196:199], v250 offset:47104
    s_waitcnt lgkmcnt(7)
    v_mfma_f32_16x16x32_bf16 v[84:87], v[204:207], v[108:111], v[84:87]
    v_exp_f32 v78, v78
    v_mfma_f32_16x16x32_bf16 v[80:83], v[204:207], v[104:107], v[80:83]
    ds_read_b128 v[200:203], v250 offset:48128
    v_cvt_pk_bf16_f32 v70, v76, v77
    v_mfma_f32_16x16x32_bf16 v[84:87], v[208:211], v[100:103], v[84:87]
    v_exp_f32 v79, v79
    v_mfma_f32_16x16x32_bf16 v[80:83], v[208:211], v[96:99], v[80:83]
    ds_read_b128 v[204:207], v248 offset:40960
    v_cvt_pk_bf16_f32 v71, v78, v79
    s_waitcnt lgkmcnt(7)
    v_mfma_f32_16x16x32_bf16 v[28:31], v[72:75], v[212:215], v[28:31]
    v_exp_f32 v120, v120
    v_mfma_f32_16x16x32_bf16 v[12:15], v[68:71], v[212:215], v[12:15]
    ds_read_b128 v[208:211], v249 offset:41984
    v_mfma_f32_16x16x32_bf16 v[24:27], v[72:75], v[216:219], v[24:27]
    v_exp_f32 v121, v121
    v_mfma_f32_16x16x32_bf16 v[8:11], v[68:71], v[216:219], v[8:11]
    ds_read_b128 v[212:215], v248 offset:43008
    v_cvt_pk_bf16_f32 v120, v120, v121
    v_mfma_f32_16x16x32_bf16 v[36:39], v[72:75], v[236:239], v[36:39]
    s_waitcnt lgkmcnt(7)
    v_mfma_f32_16x16x32_bf16 v[20:23], v[72:75], v[220:223], v[20:23]
    ds_read_b128 v[216:219], v249 offset:44032
    v_mfma_f32_16x16x32_bf16 v[4:7], v[68:71], v[220:223], v[4:7]
    v_exp_f32 v122, v122
    v_mfma_f32_16x16x32_bf16 v[16:19], v[72:75], v[224:227], v[16:19]
    v_exp_f32 v123, v123
    v_mfma_f32_16x16x32_bf16 v[0:3], v[68:71], v[224:227], v[0:3]
    ds_read_b128 v[220:223], v248 offset:45056
    s_waitcnt lgkmcnt(7)
    v_mfma_f32_16x16x32_bf16 v[64:67], v[72:75], v[228:231], v[64:67]
    v_exp_f32 v92, v92
    v_mfma_f32_16x16x32_bf16 v[48:51], v[68:71], v[228:231], v[48:51]
    ds_read_b128 v[224:227], v249 offset:46080
    v_cvt_pk_bf16_f32 v121, v122, v123
    v_mfma_f32_16x16x32_bf16 v[36:39], v[68:71], v[240:243], v[36:39]
    v_exp_f32 v93, v93
    v_mfma_f32_16x16x32_bf16 v[60:63], v[72:75], v[232:235], v[60:63]
    ds_read_b128 v[228:231], v248 offset:47104
    v_cvt_pk_bf16_f32 v92, v92, v93
    v_mfma_f32_16x16x32_bf16 v[32:35], v[68:71], v[232:235], v[32:35]
    s_waitcnt lgkmcnt(7)
    v_mfma_f32_16x16x32_bf16 v[56:59], v[72:75], v[196:199], v[56:59]
    v_exp_f32 v94, v94
    v_mfma_f32_16x16x32_bf16 v[44:47], v[68:71], v[196:199], v[44:47]
    ds_read_b128 v[232:235], v249 offset:48128
    v_mfma_f32_16x16x32_bf16 v[52:55], v[72:75], v[200:203], v[52:55]
    v_exp_f32 v95, v95
    v_mfma_f32_16x16x32_bf16 v[40:43], v[68:71], v[200:203], v[40:43]
    ds_read_b128 v[196:199], v250 offset:16384
    s_waitcnt lgkmcnt(7)
    v_mfma_f32_16x16x32_bf16 v[88:91], v[204:207], v[128:131], v[244:247]
    v_exp_f32 v84, v84
    v_mfma_f32_16x16x32_bf16 v[76:79], v[204:207], v[124:127], v[244:247]
    ds_read_b128 v[200:203], v250 offset:17408
    v_cvt_pk_bf16_f32 v93, v94, v95
    v_mfma_f32_16x16x32_bf16 v[88:91], v[208:211], v[116:119], v[88:91]
    v_exp_f32 v85, v85
    v_mfma_f32_16x16x32_bf16 v[76:79], v[208:211], v[112:115], v[76:79]
    ds_read_b128 v[204:207], v250 offset:18432
    s_waitcnt lgkmcnt(7)
    v_mfma_f32_16x16x32_bf16 v[88:91], v[212:215], v[108:111], v[88:91]
    v_exp_f32 v86, v86
    v_mfma_f32_16x16x32_bf16 v[76:79], v[212:215], v[104:107], v[76:79]
    ds_read_b128 v[208:211], v250 offset:19456
    v_cvt_pk_bf16_f32 v122, v84, v85
    v_mfma_f32_16x16x32_bf16 v[88:91], v[216:219], v[100:103], v[88:91]
    v_exp_f32 v87, v87
    v_mfma_f32_16x16x32_bf16 v[76:79], v[216:219], v[96:99], v[76:79]
    ds_read_b128 v[212:215], v250 offset:49152
    s_waitcnt lgkmcnt(7)
    v_mfma_f32_16x16x32_bf16 v[72:75], v[220:223], v[128:131], v[244:247]
    v_exp_f32 v80, v80
    v_mfma_f32_16x16x32_bf16 v[68:71], v[220:223], v[124:127], v[244:247]
    ds_read_b128 v[216:219], v250 offset:50176
    v_cvt_pk_bf16_f32 v123, v86, v87
    v_mfma_f32_16x16x32_bf16 v[72:75], v[224:227], v[116:119], v[72:75]
    v_exp_f32 v81, v81
    v_mfma_f32_16x16x32_bf16 v[68:71], v[224:227], v[112:115], v[68:71]
    ds_read_b128 v[220:223], v250 offset:51200
    s_waitcnt lgkmcnt(7)
    v_mfma_f32_16x16x32_bf16 v[72:75], v[228:231], v[108:111], v[72:75]
    v_exp_f32 v82, v82
    v_mfma_f32_16x16x32_bf16 v[68:71], v[228:231], v[104:107], v[68:71]
    ds_read_b128 v[224:227], v250 offset:52224
    v_cvt_pk_bf16_f32 v94, v80, v81
    v_mfma_f32_16x16x32_bf16 v[72:75], v[232:235], v[100:103], v[72:75]
    v_exp_f32 v83, v83
    v_mfma_f32_16x16x32_bf16 v[68:71], v[232:235], v[96:99], v[68:71]
    ds_read_b128 v[228:231], v248 offset:49152
    v_cvt_pk_bf16_f32 v95, v82, v83
    s_waitcnt lgkmcnt(7)
    v_mfma_f32_16x16x32_bf16 v[28:31], v[120:123], v[196:199], v[28:31]
    v_exp_f32 v88, v88
    v_mfma_f32_16x16x32_bf16 v[12:15], v[92:95], v[196:199], v[12:15]
    ds_read_b128 v[232:235], v249 offset:50176
    v_mfma_f32_16x16x32_bf16 v[24:27], v[120:123], v[200:203], v[24:27]
    v_exp_f32 v89, v89
    v_mfma_f32_16x16x32_bf16 v[8:11], v[92:95], v[200:203], v[8:11]
    ds_read_b128 v[196:199], v248 offset:51200
    v_cvt_pk_bf16_f32 v88, v88, v89
    v_mfma_f32_16x16x32_bf16 v[36:39], v[120:123], v[236:239], v[36:39]
    s_waitcnt lgkmcnt(7)
    v_mfma_f32_16x16x32_bf16 v[20:23], v[120:123], v[204:207], v[20:23]
    ds_read_b128 v[200:203], v249 offset:52224
    v_mfma_f32_16x16x32_bf16 v[4:7], v[92:95], v[204:207], v[4:7]
    v_exp_f32 v90, v90
    v_mfma_f32_16x16x32_bf16 v[16:19], v[120:123], v[208:211], v[16:19]
    v_exp_f32 v91, v91
    v_mfma_f32_16x16x32_bf16 v[0:3], v[92:95], v[208:211], v[0:3]
    ds_read_b128 v[204:207], v248 offset:53248
    s_waitcnt lgkmcnt(7)
    v_mfma_f32_16x16x32_bf16 v[64:67], v[120:123], v[212:215], v[64:67]
    v_exp_f32 v76, v76
    v_mfma_f32_16x16x32_bf16 v[48:51], v[92:95], v[212:215], v[48:51]
    ds_read_b128 v[208:211], v249 offset:54272
    v_cvt_pk_bf16_f32 v89, v90, v91
    v_mfma_f32_16x16x32_bf16 v[36:39], v[92:95], v[240:243], v[36:39]
    v_exp_f32 v77, v77
    v_mfma_f32_16x16x32_bf16 v[60:63], v[120:123], v[216:219], v[60:63]
    ds_read_b128 v[212:215], v248 offset:55296
    v_cvt_pk_bf16_f32 v76, v76, v77
    v_mfma_f32_16x16x32_bf16 v[32:35], v[92:95], v[216:219], v[32:35]
    s_waitcnt lgkmcnt(7)
    v_mfma_f32_16x16x32_bf16 v[56:59], v[120:123], v[220:223], v[56:59]
    v_exp_f32 v78, v78
    v_mfma_f32_16x16x32_bf16 v[44:47], v[92:95], v[220:223], v[44:47]
    ds_read_b128 v[216:219], v249 offset:56320
    v_mfma_f32_16x16x32_bf16 v[52:55], v[120:123], v[224:227], v[52:55]
    v_exp_f32 v79, v79
    v_mfma_f32_16x16x32_bf16 v[40:43], v[92:95], v[224:227], v[40:43]
    ds_read_b128 v[220:223], v250 offset:20480
    s_waitcnt lgkmcnt(7)
    v_mfma_f32_16x16x32_bf16 v[84:87], v[228:231], v[128:131], v[244:247]
    v_exp_f32 v72, v72
    v_mfma_f32_16x16x32_bf16 v[80:83], v[228:231], v[124:127], v[244:247]
    ds_read_b128 v[224:227], v250 offset:21504
    v_cvt_pk_bf16_f32 v77, v78, v79
    v_mfma_f32_16x16x32_bf16 v[84:87], v[232:235], v[116:119], v[84:87]
    v_exp_f32 v73, v73
    v_mfma_f32_16x16x32_bf16 v[80:83], v[232:235], v[112:115], v[80:83]
    ds_read_b128 v[228:231], v250 offset:22528
    s_waitcnt lgkmcnt(7)
    v_mfma_f32_16x16x32_bf16 v[84:87], v[196:199], v[108:111], v[84:87]
    v_exp_f32 v74, v74
    v_mfma_f32_16x16x32_bf16 v[80:83], v[196:199], v[104:107], v[80:83]
    ds_read_b128 v[232:235], v250 offset:23552
    v_cvt_pk_bf16_f32 v90, v72, v73
    v_mfma_f32_16x16x32_bf16 v[84:87], v[200:203], v[100:103], v[84:87]
    v_exp_f32 v75, v75
    v_mfma_f32_16x16x32_bf16 v[80:83], v[200:203], v[96:99], v[80:83]
    ds_read_b128 v[196:199], v250 offset:53248
    s_waitcnt lgkmcnt(7)
    v_mfma_f32_16x16x32_bf16 v[120:123], v[204:207], v[128:131], v[244:247]
    v_exp_f32 v68, v68
    v_mfma_f32_16x16x32_bf16 v[92:95], v[204:207], v[124:127], v[244:247]
    ds_read_b128 v[200:203], v250 offset:54272
    v_cvt_pk_bf16_f32 v91, v74, v75
    v_mfma_f32_16x16x32_bf16 v[120:123], v[208:211], v[116:119], v[120:123]
    v_exp_f32 v69, v69
    v_mfma_f32_16x16x32_bf16 v[92:95], v[208:211], v[112:115], v[92:95]
    ds_read_b128 v[204:207], v250 offset:55296
    s_waitcnt lgkmcnt(7)
    v_mfma_f32_16x16x32_bf16 v[120:123], v[212:215], v[108:111], v[120:123]
    v_exp_f32 v70, v70
    v_mfma_f32_16x16x32_bf16 v[92:95], v[212:215], v[104:107], v[92:95]
    ds_read_b128 v[208:211], v250 offset:56320
    v_cvt_pk_bf16_f32 v78, v68, v69
    v_mfma_f32_16x16x32_bf16 v[120:123], v[216:219], v[100:103], v[120:123]
    v_exp_f32 v71, v71
    v_mfma_f32_16x16x32_bf16 v[92:95], v[216:219], v[96:99], v[92:95]
    ds_read_b128 v[212:215], v248 offset:57344
    v_cvt_pk_bf16_f32 v79, v70, v71
    s_waitcnt lgkmcnt(7)
    v_mfma_f32_16x16x32_bf16 v[28:31], v[88:91], v[220:223], v[28:31]
    v_exp_f32 v84, v84
    v_mfma_f32_16x16x32_bf16 v[12:15], v[76:79], v[220:223], v[12:15]
    ds_read_b128 v[216:219], v249 offset:58368
    v_mfma_f32_16x16x32_bf16 v[24:27], v[88:91], v[224:227], v[24:27]
    v_exp_f32 v85, v85
    v_mfma_f32_16x16x32_bf16 v[8:11], v[76:79], v[224:227], v[8:11]
    ds_read_b128 v[220:223], v248 offset:59392
    v_cvt_pk_bf16_f32 v84, v84, v85
    v_mfma_f32_16x16x32_bf16 v[36:39], v[88:91], v[236:239], v[36:39]
    s_waitcnt lgkmcnt(7)
    v_mfma_f32_16x16x32_bf16 v[20:23], v[88:91], v[228:231], v[20:23]
    ds_read_b128 v[224:227], v249 offset:60416
    v_mfma_f32_16x16x32_bf16 v[4:7], v[76:79], v[228:231], v[4:7]
    v_exp_f32 v86, v86
    v_mfma_f32_16x16x32_bf16 v[16:19], v[88:91], v[232:235], v[16:19]
    v_exp_f32 v87, v87
    v_mfma_f32_16x16x32_bf16 v[0:3], v[76:79], v[232:235], v[0:3]
    ds_read_b128 v[228:231], v248 offset:61440
    s_waitcnt lgkmcnt(7)
    v_mfma_f32_16x16x32_bf16 v[64:67], v[88:91], v[196:199], v[64:67]
    v_exp_f32 v80, v80
    v_mfma_f32_16x16x32_bf16 v[48:51], v[76:79], v[196:199], v[48:51]
    ds_read_b128 v[232:235], v249 offset:62464
    v_cvt_pk_bf16_f32 v85, v86, v87
    v_mfma_f32_16x16x32_bf16 v[36:39], v[76:79], v[240:243], v[36:39]
    v_exp_f32 v81, v81
    v_mfma_f32_16x16x32_bf16 v[60:63], v[88:91], v[200:203], v[60:63]
    ds_read_b128 v[196:199], v248 offset:63488
    v_cvt_pk_bf16_f32 v80, v80, v81
    v_mfma_f32_16x16x32_bf16 v[32:35], v[76:79], v[200:203], v[32:35]
    s_waitcnt lgkmcnt(7)
    v_mfma_f32_16x16x32_bf16 v[56:59], v[88:91], v[204:207], v[56:59]
    v_exp_f32 v82, v82
    v_mfma_f32_16x16x32_bf16 v[44:47], v[76:79], v[204:207], v[44:47]
    ds_read_b128 v[200:203], v249 offset:64512
    v_mfma_f32_16x16x32_bf16 v[52:55], v[88:91], v[208:211], v[52:55]
    v_exp_f32 v83, v83
    v_mfma_f32_16x16x32_bf16 v[40:43], v[76:79], v[208:211], v[40:43]
    ds_read_b128 v[204:207], v250 offset:24576
    s_waitcnt lgkmcnt(7)
    v_mfma_f32_16x16x32_bf16 v[72:75], v[212:215], v[128:131], v[244:247]
    v_exp_f32 v120, v120
    v_mfma_f32_16x16x32_bf16 v[68:71], v[212:215], v[124:127], v[244:247]
    ds_read_b128 v[208:211], v250 offset:25600
    v_cvt_pk_bf16_f32 v81, v82, v83
    v_mfma_f32_16x16x32_bf16 v[72:75], v[216:219], v[116:119], v[72:75]
    v_exp_f32 v121, v121
    v_mfma_f32_16x16x32_bf16 v[68:71], v[216:219], v[112:115], v[68:71]
    ds_read_b128 v[212:215], v250 offset:26624
    s_waitcnt lgkmcnt(7)
    v_mfma_f32_16x16x32_bf16 v[72:75], v[220:223], v[108:111], v[72:75]
    v_exp_f32 v122, v122
    v_mfma_f32_16x16x32_bf16 v[68:71], v[220:223], v[104:107], v[68:71]
    ds_read_b128 v[216:219], v250 offset:27648
    v_cvt_pk_bf16_f32 v86, v120, v121
    v_mfma_f32_16x16x32_bf16 v[72:75], v[224:227], v[100:103], v[72:75]
    v_exp_f32 v123, v123
    v_mfma_f32_16x16x32_bf16 v[68:71], v[224:227], v[96:99], v[68:71]
    ds_read_b128 v[220:223], v250 offset:57344
    s_waitcnt lgkmcnt(7)
    v_mfma_f32_16x16x32_bf16 v[88:91], v[228:231], v[128:131], v[244:247]
    v_exp_f32 v92, v92
    v_mfma_f32_16x16x32_bf16 v[76:79], v[228:231], v[124:127], v[244:247]
    ds_read_b128 v[224:227], v250 offset:58368
    v_cvt_pk_bf16_f32 v87, v122, v123
    v_mfma_f32_16x16x32_bf16 v[88:91], v[232:235], v[116:119], v[88:91]
    v_exp_f32 v93, v93
    v_mfma_f32_16x16x32_bf16 v[76:79], v[232:235], v[112:115], v[76:79]
    ds_read_b128 v[228:231], v250 offset:59392
    s_waitcnt lgkmcnt(7)
    v_mfma_f32_16x16x32_bf16 v[88:91], v[196:199], v[108:111], v[88:91]
    v_exp_f32 v94, v94
    v_mfma_f32_16x16x32_bf16 v[76:79], v[196:199], v[104:107], v[76:79]
    ds_read_b128 v[232:235], v250 offset:60416
    v_cvt_pk_bf16_f32 v82, v92, v93
    v_mfma_f32_16x16x32_bf16 v[88:91], v[200:203], v[100:103], v[88:91]
    v_exp_f32 v95, v95
    v_mfma_f32_16x16x32_bf16 v[76:79], v[200:203], v[96:99], v[76:79]
    ds_read_b128 v[196:199], v250 offset:28672
    v_cvt_pk_bf16_f32 v83, v94, v95
    s_waitcnt lgkmcnt(7)
    v_mfma_f32_16x16x32_bf16 v[28:31], v[84:87], v[204:207], v[28:31]
    v_exp_f32 v72, v72
    v_mfma_f32_16x16x32_bf16 v[12:15], v[80:83], v[204:207], v[12:15]
    ds_read_b128 v[200:203], v250 offset:29696
    v_mfma_f32_16x16x32_bf16 v[24:27], v[84:87], v[208:211], v[24:27]
    v_exp_f32 v73, v73
    v_mfma_f32_16x16x32_bf16 v[8:11], v[80:83], v[208:211], v[8:11]
    ds_read_b128 v[204:207], v250 offset:30720
    v_cvt_pk_bf16_f32 v72, v72, v73
    v_mfma_f32_16x16x32_bf16 v[36:39], v[84:87], v[236:239], v[36:39]
    s_waitcnt lgkmcnt(7)
    v_mfma_f32_16x16x32_bf16 v[20:23], v[84:87], v[212:215], v[20:23]
    ds_read_b128 v[208:211], v250 offset:31744
    v_exp_f32 v74, v74
    v_mfma_f32_16x16x32_bf16 v[4:7], v[80:83], v[212:215], v[4:7]
    v_exp_f32 v75, v75
    v_mfma_f32_16x16x32_bf16 v[16:19], v[84:87], v[216:219], v[16:19]
    v_exp_f32 v68, v68
    v_exp_f32 v69, v69
    v_mfma_f32_16x16x32_bf16 v[0:3], v[80:83], v[216:219], v[0:3]
    ds_read_b128 v[212:215], v250 offset:61440
    v_exp_f32 v70, v70
    s_waitcnt lgkmcnt(7)
    v_mfma_f32_16x16x32_bf16 v[64:67], v[84:87], v[220:223], v[64:67]
    v_exp_f32 v71, v71
    v_mfma_f32_16x16x32_bf16 v[48:51], v[80:83], v[220:223], v[48:51]
    ds_read_b128 v[216:219], v250 offset:62464
    v_exp_f32 v88, v88
    v_mfma_f32_16x16x32_bf16 v[36:39], v[80:83], v[240:243], v[36:39]
    v_exp_f32 v89, v89
    v_cvt_pk_bf16_f32 v73, v74, v75
    v_mfma_f32_16x16x32_bf16 v[60:63], v[84:87], v[224:227], v[60:63]
    ds_read_b128 v[220:223], v250 offset:63488
    v_exp_f32 v90, v90
    v_exp_f32 v91, v91
    v_cvt_pk_bf16_f32 v68, v68, v69
    v_mfma_f32_16x16x32_bf16 v[32:35], v[80:83], v[224:227], v[32:35]
    v_exp_f32 v76, v76
    s_waitcnt lgkmcnt(7)
    v_mfma_f32_16x16x32_bf16 v[56:59], v[84:87], v[228:231], v[56:59]
    v_exp_f32 v77, v77
    v_cvt_pk_bf16_f32 v69, v70, v71
    v_cvt_pk_bf16_f32 v74, v88, v89
    v_mfma_f32_16x16x32_bf16 v[44:47], v[80:83], v[228:231], v[44:47]
    ds_read_b128 v[224:227], v250 offset:64512
    v_exp_f32 v78, v78
    v_cvt_pk_bf16_f32 v75, v90, v91
    v_mfma_f32_16x16x32_bf16 v[52:55], v[84:87], v[232:235], v[52:55]
    v_exp_f32 v79, v79
    v_cvt_pk_bf16_f32 v70, v76, v77
    v_mfma_f32_16x16x32_bf16 v[40:43], v[80:83], v[232:235], v[40:43]
    ds_read_b128 v[228:231], v248 offset:0
    v_cvt_pk_bf16_f32 v71, v78, v79
    s_waitcnt lgkmcnt(7)
    v_mfma_f32_16x16x32_bf16 v[28:31], v[72:75], v[196:199], v[28:31]
    v_mfma_f32_16x16x32_bf16 v[12:15], v[68:71], v[196:199], v[12:15]
    ds_read_b128 v[232:235], v249 offset:1024
    v_mfma_f32_16x16x32_bf16 v[24:27], v[72:75], v[200:203], v[24:27]
    v_mfma_f32_16x16x32_bf16 v[8:11], v[68:71], v[200:203], v[8:11]
    ds_read_b128 v[196:199], v248 offset:2048
    v_mfma_f32_16x16x32_bf16 v[36:39], v[72:75], v[236:239], v[36:39]
    s_waitcnt lgkmcnt(7)
    v_mfma_f32_16x16x32_bf16 v[20:23], v[72:75], v[204:207], v[20:23]
    ds_read_b128 v[200:203], v249 offset:3072
    v_mfma_f32_16x16x32_bf16 v[4:7], v[68:71], v[204:207], v[4:7]
    v_mfma_f32_16x16x32_bf16 v[16:19], v[72:75], v[208:211], v[16:19]
    v_mfma_f32_16x16x32_bf16 v[0:3], v[68:71], v[208:211], v[0:3]
    ds_read_b128 v[204:207], v248 offset:4096
    s_waitcnt lgkmcnt(7)
    v_mfma_f32_16x16x32_bf16 v[64:67], v[72:75], v[212:215], v[64:67]
    v_mfma_f32_16x16x32_bf16 v[48:51], v[68:71], v[212:215], v[48:51]
    ds_read_b128 v[208:211], v249 offset:5120
    v_mfma_f32_16x16x32_bf16 v[36:39], v[68:71], v[240:243], v[36:39]
    v_mfma_f32_16x16x32_bf16 v[60:63], v[72:75], v[216:219], v[60:63]
    ds_read_b128 v[212:215], v248 offset:6144
    v_mfma_f32_16x16x32_bf16 v[32:35], v[68:71], v[216:219], v[32:35]
    s_waitcnt lgkmcnt(7)
    v_mfma_f32_16x16x32_bf16 v[56:59], v[72:75], v[220:223], v[56:59]
    v_mfma_f32_16x16x32_bf16 v[44:47], v[68:71], v[220:223], v[44:47]
    ds_read_b128 v[216:219], v249 offset:7168
    v_mfma_f32_16x16x32_bf16 v[52:55], v[72:75], v[224:227], v[52:55]
    v_rcp_f32 v36, v36
    v_mfma_f32_16x16x32_bf16 v[40:43], v[68:71], v[224:227], v[40:43]
    ds_read_b128 v[220:223], v248 offset:8192
    s_setprio 0
    s_branch L_shared
L_exact:
    s_mov_b64 vcc, -1
    s_mov_b32 s32, 0xfffff000
L_exact_next:
    s_add_u32 s32, s32, 0x1000
    s_cmp_ge_u32 s32, 0x4000
    s_cbranch_scc1 L_done
    s_mov_b32 s33, s32
    s_mov_b32 s34, s32
    s_mov_b32 s35, s32
    s_waitcnt vmcnt(0) lgkmcnt(0)
    v_bfe_u32 v244, v252, 4, 2
    v_and_b32 v246, 0x1c000, v252
    v_lshl_add_u32 v246, v244, 10, v246
    v_bfe_u32 v244, v252, 6, 2
    v_lshl_add_u32 v246, v244, 8, v246
    v_bfe_u32 v245, v252, 8, 2
    v_lshl_add_u32 v251, v245, 4, v246
    buffer_load_dwordx4 v[128:131], v251, s[12:15], s32 offen offset:0
    buffer_load_dwordx4 v[116:119], v251, s[12:15], s32 offen offset:64
    buffer_load_dwordx4 v[108:111], v251, s[12:15], s32 offen offset:128
    buffer_load_dwordx4 v[100:103], v251, s[12:15], s32 offen offset:192
    buffer_load_dwordx4 v[124:127], v251, s[12:15], s33 offen offset:0
    buffer_load_dwordx4 v[112:115], v251, s[12:15], s33 offen offset:64
    buffer_load_dwordx4 v[104:107], v251, s[12:15], s33 offen offset:128
    buffer_load_dwordx4 v[96:99], v251, s[12:15], s33 offen offset:192
    v_mov_b32 v253, 0xff800000
    v_mov_b32 v244, v248
    v_mov_b32 v245, v249
    s_mov_b32 s3, 0
    s_waitcnt vmcnt(0)
L_exact_kt:
    ds_read_b128 v[196:199], v244 offset:0
    ds_read_b128 v[200:203], v245 offset:1024
    ds_read_b128 v[204:207], v244 offset:2048
    ds_read_b128 v[208:211], v245 offset:3072
    s_waitcnt lgkmcnt(0)
    v_mfma_f32_16x16x32_bf16 v[212:215], v[196:199], v[128:131], 0
    v_mfma_f32_16x16x32_bf16 v[212:215], v[200:203], v[116:119], v[212:215]
    v_mfma_f32_16x16x32_bf16 v[212:215], v[204:207], v[108:111], v[212:215]
    v_mfma_f32_16x16x32_bf16 v[212:215], v[208:211], v[100:103], v[212:215]
    v_add_u32 v244, 0x1000, v244
    v_add_u32 v245, 0x1000, v245
    s_nop 7
    v_max3_f32 v253, v253, v212, v213
    v_max3_f32 v253, v253, v214, v215
    s_add_u32 s3, s3, 1
    s_cmp_lt_u32 s3, 16
    s_cbranch_scc1 L_exact_kt
    v_mov_b32 v212, v253
    s_nop 1
    v_permlane32_swap_b32 v253, v212
    v_max_f32 v253, v253, v212
    v_mov_b32 v212, v253
    s_nop 1
    v_permlane16_swap_b32 v253, v212
    v_min_f32_e64 v244, -v253, -v212
    v_min_f32_e64 v245, -v253, -v212
    v_min_f32_e64 v246, -v253, -v212
    v_min_f32_e64 v247, -v253, -v212
    ds_read_b128 v[196:199], v248 offset:0
    ds_read_b128 v[200:203], v249 offset:1024
    ds_read_b128 v[204:207], v248 offset:2048
    ds_read_b128 v[208:211], v249 offset:3072
    ds_read_b128 v[212:215], v248 offset:4096
    ds_read_b128 v[216:219], v249 offset:5120
    ds_read_b128 v[220:223], v248 offset:6144
    s_waitcnt lgkmcnt(0)
    s_branch L_body
.section .rodata,"a"
.p2align 6
.amdhsa_kernel standalone__gqa_softmax__near_ridge_kernel
  .amdhsa_next_free_vgpr 256
  .amdhsa_next_free_sgpr 96
  .amdhsa_accum_offset 256
  .amdhsa_group_segment_fixed_size 0
  .amdhsa_kernarg_size 48
  .amdhsa_user_sgpr_count 2
  .amdhsa_user_sgpr_kernarg_segment_ptr 1
  .amdhsa_system_sgpr_workgroup_id_x 1
.end_amdhsa_kernel
```
